```python
import torch

def _softmax(x, axis=-1):
    return torch.softmax(x, dim=axis)
def _gelu(x):
    return torch.nn.functional.gelu(x, approximate="tanh")
def _silu(x):
    return torch.nn.functional.silu(x)
def _sigmoid(x):
    return torch.sigmoid(x)
def _layernorm(x, axis=-1, eps=1e-5):
    m = x.mean(dim=axis, keepdim=True)
    v = x.var(dim=axis, keepdim=True, unbiased=False)
    return (x - m) / torch.sqrt(v + eps)
def _scatter_add(tgt, idx, src, axis=0):
    return tgt.clone().index_add_(axis, idx, src)
def _segment_sum(src, seg, n):
    out = torch.zeros((n,) + src.shape[1:], dtype=src.dtype)
    return out.index_add_(0, seg, src)
def _pad(x, pw):
    flat = tuple(v for pair in reversed(pw) for v in pair)
    return torch.nn.functional.pad(x, flat)

kernel_name = 'interleave_layers__sliding_block__geglu_ffn__prompt'

def setup_inputs():

    _w = (lambda a: (lambda t: t.to(torch.bfloat16) if t.is_floating_point() else t)(torch.as_tensor(a)))
    def _A_setup():
        B, S, D = 1, 2048, 512
        return {
            "x": _w((lambda *s: torch.randn(*s, dtype=torch.bfloat16) * 0.05)(B, S, D)),
            "wqkv": _w((lambda *s: torch.randn(*s, dtype=torch.bfloat16) * 0.05)(D, 3 * D)),
            "wo": _w((lambda *s: torch.randn(*s, dtype=torch.bfloat16) * 0.05)(D, D)),
        }
    _A_in = _A_setup()

    def _B_setup():
        B, S, D, F = 1, 2048, 512, 1792
        return {
            "x": _w((lambda *s: torch.randn(*s, dtype=torch.bfloat16) * 0.05)(B, S, D)),
            "w_gate": _w((lambda *s: torch.randn(*s, dtype=torch.bfloat16) * 0.05)(D, F)),
            "w_up": _w((lambda *s: torch.randn(*s, dtype=torch.bfloat16) * 0.05)(D, F)),
            "w_down": _w((lambda *s: torch.randn(*s, dtype=torch.bfloat16) * 0.05)(F, D)),
        }
    _B_in = _B_setup()

    return {
        "A_x": _A_in["x"],
        "A_wqkv": _A_in["wqkv"],
        "A_wo": _A_in["wo"],
        "B_x": _B_in["x"],
        "B_w_gate": _B_in["w_gate"],
        "B_w_up": _B_in["w_up"],
        "B_w_down": _B_in["w_down"],
    }

def reference(A_x, A_wqkv, A_wo, B_x, B_w_gate, B_w_up, B_w_down):
    def _A_ref(x, wqkv, wo):
        B, S, D = x.shape
        H = 32; Dh = D // H; W = 256
        qkv = (lambda x, *d: x.permute(*d))((x @ wqkv).reshape(B, S, 3, H, Dh), 2, 0, 3, 1, 4)
        q, k, v = qkv[0], qkv[1], qkv[2]
        scores = torch.einsum("bhqd,bhkd->bhqk", q, k) * (Dh ** -0.5)
        idx = torch.arange(S)
        mask = (idx[:, None] - idx[None, :] >= 0) & (idx[:, None] - idx[None, :] < W)
        scores = torch.where(mask[None, None], scores, -1e9)
        p = _softmax(scores, axis=-1)
        o = torch.einsum("bhqk,bhkd->bhqd", p, v)
        return (lambda x, *d: x.permute(*d))(o, 0, 2, 1, 3).reshape(B, S, D) @ wo

    def _B_ref(x, w_gate, w_up, w_down):
        return (_gelu(x @ w_gate) * (x @ w_up)) @ w_down

    x = A_x
    x = x + _A_ref(_layernorm(x, axis=-1), A_wqkv, A_wo)
    x = x + _B_ref(_layernorm(x, axis=-1), B_w_gate, B_w_up, B_w_down)
    x = x + _A_ref(_layernorm(x, axis=-1), A_wqkv, A_wo)
    x = x + _B_ref(_layernorm(x, axis=-1), B_w_gate, B_w_up, B_w_down)
    return x
```

```asm
; @launch kernel=mega_kernel grid=(256,1,1) block=(768,1,1) lds=163840
.amdgcn_target "amdgcn-amd-amdhsa--gfx950"
.text
.globl mega_kernel
.p2align 8
.type mega_kernel,@function
mega_kernel:
    s_cmp_ge_u32 s2, 256
    s_cbranch_scc1 mega_kernel_end
    s_load_dwordx2 s[8:9], s[0:1], 72
    s_load_dwordx2 s[10:11], s[0:1], 56
    s_load_dwordx2 s[66:67], s[0:1], 0
    s_load_dwordx2 s[68:69], s[0:1], 8
    s_load_dwordx2 s[70:71], s[0:1], 16
    s_load_dwordx4 s[72:75], s[0:1], 32
    s_load_dwordx2 s[76:77], s[0:1], 48
    s_load_dwordx2 s[78:79], s[0:1], 64
    v_lshrrev_b32 v2, 6, v0
    v_and_b32 v0, 63, v0
    v_readfirstlane_b32 s19, v2
    v_lshlrev_b32 v1, 4, v0
    s_and_b32 s31, s2, 7
    s_lshr_b32 s32, s2, 3
    s_lshr_b32 s20, s31, 1
    s_lshl_b32 s20, s20, 3
    s_and_b32 s33, s32, 7
    s_add_u32 s20, s20, s33
    s_and_b32 s21, s31, 1
    s_lshl_b32 s21, s21, 2
    s_lshr_b32 s33, s32, 3
    s_add_u32 s21, s21, s33
    s_mov_b32 s22, s20
    s_mov_b32 s23, s21
    s_and_b32 s28, s31, 1
    s_lshl_b32 s28, s28, 3
    s_and_b32 s33, s32, 7
    s_add_u32 s28, s28, s33
    s_lshr_b32 s29, s31, 1
    s_lshl_b32 s29, s29, 2
    s_lshr_b32 s33, s32, 3
    s_add_u32 s29, s29, s33
    s_mov_b32 s16, 0
    s_mov_b32 s17, 60817408
    s_mov_b32 s18, 0
    s_waitcnt lgkmcnt(0)
    s_mov_b32 s12, s8
    s_and_b32 s13, s9, 0xffff
    s_mov_b32 s14, 67108864
    s_mov_b32 s15, 0x00020000
    s_mov_b32 s24, s10
    s_and_b32 s25, s11, 0xffff
    s_mov_b32 s26, 2097152
    s_mov_b32 s27, 0x00020000
    s_cmp_ge_u32 s19, 8
    s_cbranch_scc1 mega_kernel_loader
    s_mov_b32 s4, s66
    s_and_b32 s5, s67, 0xffff
    s_mov_b32 s6, 2097152
    s_mov_b32 s7, 0x00020000
    v_lshrrev_b32 v2, 3, v0
    v_and_b32 v3, 7, v0
    v_lshrrev_b32 v5, 4, v0
    v_xor_b32 v3, v3, v5
    v_lshlrev_b32 v3, 4, v3
    v_lshl_add_u32 v6, v2, 10, v3
    v_xor_b32 v7, 64, v6
    s_lshl_b32 s38, s22, 16
    s_lshl_b32 s39, s19, 7
    s_add_u32 s39, s39, s38
    s_lshl_b32 s40, s19, 13
    s_add_u32 m0, s40, 0
    s_add_u32 s42, s39, 0
    buffer_load_dwordx4 v6, s[4:7], s42 offen lds
    s_add_u32 m0, s40, 1024
    s_add_u32 s42, s39, 8192
    buffer_load_dwordx4 v7, s[4:7], s42 offen lds
    s_add_u32 m0, s40, 2048
    s_add_u32 s42, s39, 16384
    buffer_load_dwordx4 v6, s[4:7], s42 offen lds
    s_add_u32 m0, s40, 3072
    s_add_u32 s42, s39, 24576
    buffer_load_dwordx4 v7, s[4:7], s42 offen lds
    s_add_u32 m0, s40, 4096
    s_add_u32 s42, s39, 32768
    buffer_load_dwordx4 v6, s[4:7], s42 offen lds
    s_add_u32 m0, s40, 5120
    s_add_u32 s42, s39, 40960
    buffer_load_dwordx4 v7, s[4:7], s42 offen lds
    s_add_u32 m0, s40, 6144
    s_add_u32 s42, s39, 49152
    buffer_load_dwordx4 v6, s[4:7], s42 offen lds
    s_add_u32 m0, s40, 7168
    s_add_u32 s42, s39, 57344
    buffer_load_dwordx4 v7, s[4:7], s42 offen lds
    v_and_b32 v2, 31, v0
    v_lshrrev_b32 v3, 5, v0
    v_bfe_u32 v4, v0, 1, 3
    v_xor_b32 v4, v3, v4
    v_lshlrev_b32 v4, 4, v4
    v_lshl_add_u32 v4, v2, 7, v4
    v_add_u32 v48, s40, v4
    v_xor_b32 v49, 32, v48
    v_xor_b32 v50, 64, v48
    v_xor_b32 v51, 96, v48
    v_mov_b32 v52, 0x3f803f80
    v_mov_b32 v40, 0
    v_mov_b32 v41, 0
    v_mov_b32 v42, 0
    v_mov_b32 v43, 0
    v_mov_b32 v44, 0
    v_mov_b32 v45, 0
    v_mov_b32 v46, 0
    v_mov_b32 v47, 0
    v_lshlrev_b32 v5, 4, v2
    v_lshl_add_u32 v5, v3, 3, v5
    s_lshl_b32 s42, s19, 9
    s_add_u32 s42, s42, 147456
    v_add_u32 v5, s42, v5
    s_waitcnt vmcnt(0)
    ds_read_b128 v[8:11], v48 offset:0
    ds_read_b128 v[12:15], v49 offset:0
    ds_read_b128 v[16:19], v50 offset:0
    ds_read_b128 v[20:23], v51 offset:0
    ds_read_b128 v[24:27], v48 offset:4096
    ds_read_b128 v[28:31], v49 offset:4096
    ds_read_b128 v[32:35], v50 offset:4096
    ds_read_b128 v[36:39], v51 offset:4096
    s_waitcnt lgkmcnt(0)
    s_cmp_lg_u32 s21, s19
    s_cbranch_scc1 mega_kernel_p0nr1
    s_lshl_b32 s42, s21, 12
    s_add_u32 s42, s42, s38
    s_add_u32 s42, s42, 18874368
    s_add_u32 s43, s42, 32768
    buffer_store_dwordx4 v[8:11], v1, s[12:15], s42 offen offset:0 sc1
    buffer_store_dwordx4 v[12:15], v1, s[12:15], s42 offen offset:1024 sc1
    buffer_store_dwordx4 v[16:19], v1, s[12:15], s42 offen offset:2048 sc1
    buffer_store_dwordx4 v[20:23], v1, s[12:15], s42 offen offset:3072 sc1
    buffer_store_dwordx4 v[24:27], v1, s[12:15], s43 offen offset:0 sc1
    buffer_store_dwordx4 v[28:31], v1, s[12:15], s43 offen offset:1024 sc1
    buffer_store_dwordx4 v[32:35], v1, s[12:15], s43 offen offset:2048 sc1
    buffer_store_dwordx4 v[36:39], v1, s[12:15], s43 offen offset:3072 sc1
mega_kernel_p0nr1:
    v_dot2_f32_bf16 v40, v8, v52, v40
    v_dot2_f32_bf16 v41, v8, v8, v41
    v_dot2_f32_bf16 v42, v24, v52, v42
    v_dot2_f32_bf16 v43, v24, v24, v43
    v_dot2_f32_bf16 v40, v9, v52, v40
    v_dot2_f32_bf16 v41, v9, v9, v41
    v_dot2_f32_bf16 v42, v25, v52, v42
    v_dot2_f32_bf16 v43, v25, v25, v43
    v_dot2_f32_bf16 v40, v10, v52, v40
    v_dot2_f32_bf16 v41, v10, v10, v41
    v_dot2_f32_bf16 v42, v26, v52, v42
    v_dot2_f32_bf16 v43, v26, v26, v43
    v_dot2_f32_bf16 v40, v11, v52, v40
    v_dot2_f32_bf16 v41, v11, v11, v41
    v_dot2_f32_bf16 v42, v27, v52, v42
    v_dot2_f32_bf16 v43, v27, v27, v43
    v_dot2_f32_bf16 v40, v12, v52, v40
    v_dot2_f32_bf16 v41, v12, v12, v41
    v_dot2_f32_bf16 v42, v28, v52, v42
    v_dot2_f32_bf16 v43, v28, v28, v43
    v_dot2_f32_bf16 v40, v13, v52, v40
    v_dot2_f32_bf16 v41, v13, v13, v41
    v_dot2_f32_bf16 v42, v29, v52, v42
    v_dot2_f32_bf16 v43, v29, v29, v43
    v_dot2_f32_bf16 v40, v14, v52, v40
    v_dot2_f32_bf16 v41, v14, v14, v41
    v_dot2_f32_bf16 v42, v30, v52, v42
    v_dot2_f32_bf16 v43, v30, v30, v43
    v_dot2_f32_bf16 v40, v15, v52, v40
    v_dot2_f32_bf16 v41, v15, v15, v41
    v_dot2_f32_bf16 v42, v31, v52, v42
    v_dot2_f32_bf16 v43, v31, v31, v43
    v_dot2_f32_bf16 v40, v16, v52, v40
    v_dot2_f32_bf16 v41, v16, v16, v41
    v_dot2_f32_bf16 v42, v32, v52, v42
    v_dot2_f32_bf16 v43, v32, v32, v43
    v_dot2_f32_bf16 v40, v17, v52, v40
    v_dot2_f32_bf16 v41, v17, v17, v41
    v_dot2_f32_bf16 v42, v33, v52, v42
    v_dot2_f32_bf16 v43, v33, v33, v43
    v_dot2_f32_bf16 v40, v18, v52, v40
    v_dot2_f32_bf16 v41, v18, v18, v41
    v_dot2_f32_bf16 v42, v34, v52, v42
    v_dot2_f32_bf16 v43, v34, v34, v43
    v_dot2_f32_bf16 v40, v19, v52, v40
    v_dot2_f32_bf16 v41, v19, v19, v41
    v_dot2_f32_bf16 v42, v35, v52, v42
    v_dot2_f32_bf16 v43, v35, v35, v43
    v_dot2_f32_bf16 v40, v20, v52, v40
    v_dot2_f32_bf16 v41, v20, v20, v41
    v_dot2_f32_bf16 v42, v36, v52, v42
    v_dot2_f32_bf16 v43, v36, v36, v43
    v_dot2_f32_bf16 v40, v21, v52, v40
    v_dot2_f32_bf16 v41, v21, v21, v41
    v_dot2_f32_bf16 v42, v37, v52, v42
    v_dot2_f32_bf16 v43, v37, v37, v43
    v_dot2_f32_bf16 v40, v22, v52, v40
    v_dot2_f32_bf16 v41, v22, v22, v41
    v_dot2_f32_bf16 v42, v38, v52, v42
    v_dot2_f32_bf16 v43, v38, v38, v43
    v_dot2_f32_bf16 v40, v23, v52, v40
    v_dot2_f32_bf16 v41, v23, v23, v41
    v_dot2_f32_bf16 v42, v39, v52, v42
    v_dot2_f32_bf16 v43, v39, v39, v43
    s_nop 0
    ds_write_b64 v5, v[40:41]
    s_nop 0
    ds_write_b64 v5, v[42:43] offset:4096
    s_barrier
    s_waitcnt vmcnt(0) lgkmcnt(0)
    s_barrier
mega_kernel_ctop:
    s_cmp_ge_u32 s19, 4
    s_cbranch_scc1 mega_kernel_p1h18
    s_and_b32 s35, s19, 1
    s_lshr_b32 s36, s19, 1
    s_lshl_b32 s37, s22, 1
    s_add_u32 s37, s37, s35
    s_lshl_b32 s38, s35, 12
    s_cmp_lg_u32 s18, 0
    s_cbranch_scc1 mega_kernel_ai120
    v_and_b32 v2, 31, v0
    v_lshrrev_b32 v3, 5, v0
    v_bfe_u32 v4, v0, 1, 3
    v_xor_b32 v3, v3, v4
    v_lshlrev_b32 v3, 4, v3
    v_lshl_add_u32 v2, v2, 7, v3
    v_add_u32 v92, s38, v2
    v_xor_b32 v93, 32, v92
    v_xor_b32 v94, 64, v92
    v_xor_b32 v95, 96, v92
    s_branch mega_kernel_ai221
mega_kernel_ai120:
    v_add_u32 v92, s38, v1
    v_add_u32 v93, 1024, v92
    v_add_u32 v94, 2048, v92
    v_add_u32 v95, 3072, v92
mega_kernel_ai221:
    s_lshl_b32 s39, s36, 10
    s_add_u32 s39, s39, 65536
    v_add_u32 v96, s39, v1
    v_add_u32 v97, 65536, v96
    v_mov_b32 v8, 0
    v_mov_b32 v9, 0
    v_mov_b32 v10, 0
    v_mov_b32 v11, 0
    v_mov_b32 v12, 0
    v_mov_b32 v13, 0
    v_mov_b32 v14, 0
    v_mov_b32 v15, 0
    v_mov_b32 v16, 0
    v_mov_b32 v17, 0
    v_mov_b32 v18, 0
    v_mov_b32 v19, 0
    v_mov_b32 v20, 0
    v_mov_b32 v21, 0
    v_mov_b32 v22, 0
    v_mov_b32 v23, 0
    v_mov_b32 v24, 0
    v_mov_b32 v25, 0
    v_mov_b32 v26, 0
    v_mov_b32 v27, 0
    v_mov_b32 v28, 0
    v_mov_b32 v29, 0
    v_mov_b32 v30, 0
    v_mov_b32 v31, 0
    v_mov_b32 v32, 0
    v_mov_b32 v33, 0
    v_mov_b32 v34, 0
    v_mov_b32 v35, 0
    v_mov_b32 v36, 0
    v_mov_b32 v37, 0
    v_mov_b32 v38, 0
    v_mov_b32 v39, 0
    v_mov_b32 v40, 0
    v_mov_b32 v41, 0
    v_mov_b32 v42, 0
    v_mov_b32 v43, 0
    v_mov_b32 v44, 0
    v_mov_b32 v45, 0
    v_mov_b32 v46, 0
    v_mov_b32 v47, 0
    v_mov_b32 v48, 0
    v_mov_b32 v49, 0
    v_mov_b32 v50, 0
    v_mov_b32 v51, 0
    v_mov_b32 v52, 0
    v_mov_b32 v53, 0
    v_mov_b32 v54, 0
    v_mov_b32 v55, 0
    v_and_b32 v2, 31, v0
    v_lshrrev_b32 v3, 5, v0
    v_lshlrev_b32 v4, 4, v2
    v_lshl_add_u32 v4, v3, 11, v4
    s_lshl_b32 s46, s35, 12
    s_add_u32 s46, s46, 147456
    v_add_u32 v108, s46, v4
    s_lshl_b32 s46, s36, 10
    s_add_u32 s46, s46, 155648
    v_add_u32 v107, s46, v1
    s_lshl_b32 s44, s19, 7
    s_add_u32 s44, s44, 161792
    v_lshlrev_b32 v2, 2, v2
    v_lshlrev_b32 v3, 4, v3
    v_add_u32 v104, s44, v2
    v_add_u32 v105, s44, v3
    s_lshl_b32 s44, s36, 12
    s_lshl_b32 s46, s35, 10
    s_add_u32 s44, s44, s46
    s_add_u32 s44, s44, 114688
    v_add_u32 v109, s44, v1
    s_lshl_b32 s45, s23, 2
    s_lshl_b32 s46, s36, 1
    s_add_u32 s45, s45, s46
    s_lshl_b32 s45, s45, 16
    s_lshl_b32 s46, s37, 10
    s_add_u32 s45, s45, s46
    s_add_u32 s45, s45, s16
    s_add_u32 s46, s45, 2097152
    s_add_u32 s47, s46, 65536
    s_add_u32 s45, s45, 4194304
    v_bfe_u32 v2, v0, 4, 1
    v_lshlrev_b32 v106, 16, v2
    v_lshrrev_b32 v2, 5, v0
    v_lshl_add_u32 v106, v2, 9, v106
    v_and_b32 v2, 15, v0
    v_lshl_add_u32 v106, v2, 4, v106
    s_barrier
    ds_read_b128 v[56:59], v92 offset:0
    ds_read_b128 v[60:63], v96 offset:0
    ds_read_b128 v[64:67], v96 offset:8192
    ds_read_b128 v[68:71], v93 offset:0
    ds_read_b128 v[72:75], v96 offset:2048
    ds_read_b128 v[76:79], v96 offset:10240
    s_waitcnt lgkmcnt(3)
    v_mfma_f32_32x32x16_bf16 v[8:23], v[60:63], v[56:59], v[8:23]
    ds_read_b128 v[80:83], v94 offset:0
    ds_read_b128 v[84:87], v96 offset:4096
    v_mfma_f32_32x32x16_bf16 v[24:39], v[56:59], v[64:67], v[24:39]
    ds_read_b128 v[88:91], v96 offset:12288
    s_waitcnt lgkmcnt(3)
    v_mfma_f32_32x32x16_bf16 v[8:23], v[72:75], v[68:71], v[8:23]
    ds_read_b128 v[56:59], v95 offset:0
    ds_read_b128 v[60:63], v96 offset:6144
    v_mfma_f32_32x32x16_bf16 v[24:39], v[68:71], v[76:79], v[24:39]
    ds_read_b128 v[64:67], v96 offset:14336
    s_waitcnt lgkmcnt(3)
    s_barrier
    v_mfma_f32_32x32x16_bf16 v[8:23], v[84:87], v[80:83], v[8:23]
    ds_read_b128 v[68:71], v92 offset:8192
    ds_read_b128 v[72:75], v96 offset:16384
    v_mfma_f32_32x32x16_bf16 v[24:39], v[80:83], v[88:91], v[24:39]
    ds_read_b128 v[76:79], v96 offset:24576
    s_waitcnt lgkmcnt(3)
    v_mfma_f32_32x32x16_bf16 v[8:23], v[60:63], v[56:59], v[8:23]
    ds_read_b128 v[80:83], v93 offset:8192
    ds_read_b128 v[84:87], v96 offset:18432
    v_mfma_f32_32x32x16_bf16 v[24:39], v[56:59], v[64:67], v[24:39]
    ds_read_b128 v[88:91], v96 offset:26624
    s_waitcnt lgkmcnt(3)
    v_mfma_f32_32x32x16_bf16 v[8:23], v[72:75], v[68:71], v[8:23]
    ds_read_b128 v[56:59], v94 offset:8192
    ds_read_b128 v[60:63], v96 offset:20480
    v_mfma_f32_32x32x16_bf16 v[24:39], v[68:71], v[76:79], v[24:39]
    ds_read_b128 v[64:67], v96 offset:28672
    s_waitcnt lgkmcnt(3)
    v_mfma_f32_32x32x16_bf16 v[8:23], v[84:87], v[80:83], v[8:23]
    ds_read_b128 v[68:71], v95 offset:8192
    ds_read_b128 v[72:75], v96 offset:22528
    v_mfma_f32_32x32x16_bf16 v[24:39], v[80:83], v[88:91], v[24:39]
    ds_read_b128 v[76:79], v96 offset:30720
    s_waitcnt lgkmcnt(3)
    s_barrier
    v_mfma_f32_32x32x16_bf16 v[8:23], v[60:63], v[56:59], v[8:23]
    ds_read_b128 v[80:83], v92 offset:16384
    ds_read_b128 v[84:87], v96 offset:32768
    v_mfma_f32_32x32x16_bf16 v[24:39], v[56:59], v[64:67], v[24:39]
    ds_read_b128 v[88:91], v96 offset:40960
    s_waitcnt lgkmcnt(3)
    v_mfma_f32_32x32x16_bf16 v[8:23], v[72:75], v[68:71], v[8:23]
    ds_read_b128 v[56:59], v93 offset:16384
    ds_read_b128 v[60:63], v96 offset:34816
    v_mfma_f32_32x32x16_bf16 v[24:39], v[68:71], v[76:79], v[24:39]
    ds_read_b128 v[64:67], v96 offset:43008
    s_waitcnt lgkmcnt(3)
    v_mfma_f32_32x32x16_bf16 v[8:23], v[84:87], v[80:83], v[8:23]
    ds_read_b128 v[68:71], v94 offset:16384
    ds_read_b128 v[72:75], v96 offset:36864
    v_mfma_f32_32x32x16_bf16 v[24:39], v[80:83], v[88:91], v[24:39]
    ds_read_b128 v[76:79], v96 offset:45056
    ds_read_b128 v[142:145], v108 offset:0
    ds_read_b128 v[146:149], v108 offset:512
    ds_read_b128 v[150:153], v108 offset:1024
    ds_read_b128 v[154:157], v108 offset:1536
    s_waitcnt lgkmcnt(3)
    v_mfma_f32_32x32x16_bf16 v[8:23], v[60:63], v[56:59], v[8:23]
    ds_read_b128 v[80:83], v95 offset:16384
    ds_read_b128 v[84:87], v96 offset:38912
    v_mfma_f32_32x32x16_bf16 v[24:39], v[56:59], v[64:67], v[24:39]
    ds_read_b128 v[88:91], v96 offset:47104
    s_waitcnt lgkmcnt(3)
    s_barrier
    v_mfma_f32_32x32x16_bf16 v[8:23], v[72:75], v[68:71], v[8:23]
    ds_read_b128 v[56:59], v92 offset:24576
    ds_read_b128 v[60:63], v96 offset:49152
    v_add_f32 v102, v142, v144
    v_add_f32 v103, v143, v145
    v_add_f32 v102, v102, v146
    v_mfma_f32_32x32x16_bf16 v[24:39], v[68:71], v[76:79], v[24:39]
    ds_read_b128 v[64:67], v96 offset:57344
    v_add_f32 v103, v103, v147
    v_add_f32 v102, v102, v148
    v_add_f32 v103, v103, v149
    s_waitcnt lgkmcnt(3)
    v_mfma_f32_32x32x16_bf16 v[8:23], v[84:87], v[80:83], v[8:23]
    ds_read_b128 v[68:71], v93 offset:24576
    ds_read_b128 v[72:75], v96 offset:51200
    v_add_f32 v102, v102, v150
    v_add_f32 v103, v103, v151
    v_add_f32 v102, v102, v152
    v_mfma_f32_32x32x16_bf16 v[24:39], v[80:83], v[88:91], v[24:39]
    ds_read_b128 v[76:79], v96 offset:59392
    v_add_f32 v103, v103, v153
    v_add_f32 v102, v102, v154
    v_add_f32 v103, v103, v155
    s_waitcnt lgkmcnt(3)
    v_mfma_f32_32x32x16_bf16 v[8:23], v[60:63], v[56:59], v[8:23]
    ds_read_b128 v[80:83], v94 offset:24576
    ds_read_b128 v[84:87], v96 offset:53248
    v_add_f32 v102, v102, v156
    v_add_f32 v103, v103, v157
    v_mov_b32 v100, v102
    v_mfma_f32_32x32x16_bf16 v[24:39], v[56:59], v[64:67], v[24:39]
    ds_read_b128 v[88:91], v96 offset:61440
    v_mov_b32 v101, v103
    v_permlane32_swap_b32 v100, v102
    s_nop 0
    v_permlane32_swap_b32 v101, v103
    s_waitcnt lgkmcnt(3)
    v_mfma_f32_32x32x16_bf16 v[8:23], v[72:75], v[68:71], v[8:23]
    ds_read_b128 v[56:59], v95 offset:24576
    ds_read_b128 v[60:63], v96 offset:55296
    v_add_f32 v102, v102, v100
    v_add_f32 v103, v103, v101
    v_mul_f32 v102, 0x3b000000, v102
    v_mfma_f32_32x32x16_bf16 v[24:39], v[68:71], v[76:79], v[24:39]
    ds_read_b128 v[64:67], v96 offset:63488
    v_mul_f32 v103, 0x3b000000, v103
    v_fma_f32 v103, -v102, v102, v103
    v_max_f32 v103, 0, v103
    s_waitcnt lgkmcnt(3)
    s_barrier
    v_mfma_f32_32x32x16_bf16 v[8:23], v[84:87], v[80:83], v[8:23]
    ds_read_b128 v[68:71], v92 offset:32768
    ds_read_b128 v[72:75], v97 offset:0
    v_cvt_pk_bf16_f32 v98, v102, v102
    v_lshlrev_b32 v98, 16, v98
    v_cvt_pk_bf16_f32 v100, v103, v103
    v_mfma_f32_32x32x16_bf16 v[24:39], v[80:83], v[88:91], v[24:39]
    ds_read_b128 v[76:79], v97 offset:8192
    v_lshlrev_b32 v100, 16, v100
    v_add_f32 v100, 0x3727c5ac, v100
    v_cvt_pk_bf16_f32 v100, v100, v100
    s_waitcnt lgkmcnt(3)
    v_mfma_f32_32x32x16_bf16 v[8:23], v[60:63], v[56:59], v[8:23]
    ds_read_b128 v[80:83], v93 offset:32768
    ds_read_b128 v[84:87], v97 offset:2048
    v_lshlrev_b32 v100, 16, v100
    v_sqrt_f32 v100, v100
    s_nop 0
    v_cvt_pk_bf16_f32 v100, v100, v100
    v_mfma_f32_32x32x16_bf16 v[24:39], v[56:59], v[64:67], v[24:39]
    ds_read_b128 v[88:91], v97 offset:10240
    v_lshlrev_b32 v100, 16, v100
    v_rcp_f32 v99, v100
    s_nop 0
    ds_write_b32 v104, v99
    s_waitcnt lgkmcnt(3)
    v_mfma_f32_32x32x16_bf16 v[8:23], v[72:75], v[68:71], v[8:23]
    ds_read_b128 v[56:59], v94 offset:32768
    ds_read_b128 v[60:63], v97 offset:4096
    v_xor_b32 v114, 0x80000000, v98
    v_lshrrev_b32 v115, 16, v114
    v_or_b32 v114, v114, v115
    v_mfma_f32_32x32x16_bf16 v[24:39], v[68:71], v[76:79], v[24:39]
    ds_read_b128 v[64:67], v97 offset:12288
    v_mov_b32 v116, 0
    v_mov_b32 v117, 0
    v_mul_f32 v101, 0x3eb8aa3b, v99
    s_waitcnt lgkmcnt(3)
    v_mfma_f32_32x32x16_bf16 v[8:23], v[84:87], v[80:83], v[8:23]
    ds_read_b128 v[68:71], v95 offset:32768
    ds_read_b128 v[72:75], v97 offset:6144
    v_mfma_f32_32x32x16_bf16 v[24:39], v[80:83], v[88:91], v[24:39]
    ds_read_b128 v[76:79], v97 offset:14336
    s_waitcnt lgkmcnt(3)
    s_barrier
    v_mfma_f32_32x32x16_bf16 v[8:23], v[60:63], v[56:59], v[8:23]
    ds_read_b128 v[80:83], v92 offset:40960
    ds_read_b128 v[84:87], v96 offset:0
    v_mfma_f32_32x32x16_bf16 v[24:39], v[56:59], v[64:67], v[24:39]
    ds_read_b128 v[88:91], v96 offset:8192
    s_waitcnt lgkmcnt(3)
    v_mfma_f32_32x32x16_bf16 v[8:23], v[72:75], v[68:71], v[8:23]
    ds_read_b128 v[56:59], v93 offset:40960
    ds_read_b128 v[60:63], v96 offset:2048
    v_mfma_f32_32x32x16_bf16 v[24:39], v[68:71], v[76:79], v[24:39]
    ds_read_b128 v[64:67], v96 offset:10240
    s_waitcnt lgkmcnt(3)
    v_mfma_f32_32x32x16_bf16 v[8:23], v[84:87], v[80:83], v[8:23]
    ds_read_b128 v[68:71], v94 offset:40960
    ds_read_b128 v[72:75], v96 offset:4096
    v_mfma_f32_32x32x16_bf16 v[24:39], v[80:83], v[88:91], v[24:39]
    ds_read_b128 v[76:79], v96 offset:12288
    ds_read_b128 v[126:129], v105 offset:0
    ds_read_b128 v[130:133], v105 offset:32
    ds_read_b128 v[134:137], v105 offset:64
    ds_read_b128 v[138:141], v105 offset:96
    ds_read_b128 v[118:121], v107 offset:2048
    ds_read_b128 v[122:125], v107 offset:4096
    ds_read_b128 v[142:145], v107
    s_waitcnt lgkmcnt(3)
    v_mfma_f32_32x32x16_bf16 v[8:23], v[60:63], v[56:59], v[8:23]
    ds_read_b128 v[80:83], v95 offset:40960
    ds_read_b128 v[84:87], v96 offset:6144
    v_mfma_f32_32x32x16_bf16 v[24:39], v[56:59], v[64:67], v[24:39]
    ds_read_b128 v[88:91], v96 offset:14336
    s_waitcnt lgkmcnt(3)
    s_barrier
    v_mfma_f32_32x32x16_bf16 v[8:23], v[118:121], v[114:117], v[8:23]
    v_mfma_f32_32x32x16_bf16 v[24:39], v[114:117], v[122:125], v[24:39]
    v_mfma_f32_32x32x16_bf16 v[40:55], v[142:145], v[114:117], v[40:55]
    v_mfma_f32_32x32x16_bf16 v[8:23], v[72:75], v[68:71], v[8:23]
    ds_read_b128 v[56:59], v92 offset:49152
    ds_read_b128 v[60:63], v96 offset:16384
    v_mfma_f32_32x32x16_bf16 v[24:39], v[68:71], v[76:79], v[24:39]
    ds_read_b128 v[64:67], v96 offset:24576
    s_waitcnt lgkmcnt(3)
    v_mfma_f32_32x32x16_bf16 v[8:23], v[84:87], v[80:83], v[8:23]
    ds_read_b128 v[68:71], v93 offset:49152
    ds_read_b128 v[72:75], v96 offset:18432
    v_mfma_f32_32x32x16_bf16 v[24:39], v[80:83], v[88:91], v[24:39]
    ds_read_b128 v[76:79], v96 offset:26624
    s_waitcnt lgkmcnt(3)
    v_mfma_f32_32x32x16_bf16 v[8:23], v[60:63], v[56:59], v[8:23]
    ds_read_b128 v[80:83], v94 offset:49152
    ds_read_b128 v[84:87], v96 offset:20480
    v_mfma_f32_32x32x16_bf16 v[24:39], v[56:59], v[64:67], v[24:39]
    ds_read_b128 v[88:91], v96 offset:28672
    s_waitcnt lgkmcnt(3)
    v_mfma_f32_32x32x16_bf16 v[8:23], v[72:75], v[68:71], v[8:23]
    ds_read_b128 v[56:59], v95 offset:49152
    ds_read_b128 v[60:63], v96 offset:22528
    v_mfma_f32_32x32x16_bf16 v[24:39], v[68:71], v[76:79], v[24:39]
    ds_read_b128 v[64:67], v96 offset:30720
    s_waitcnt lgkmcnt(3)
    s_barrier
    v_mfma_f32_32x32x16_bf16 v[8:23], v[84:87], v[80:83], v[8:23]
    ds_read_b128 v[68:71], v92 offset:57344
    ds_read_b128 v[72:75], v96 offset:32768
    v_mfma_f32_32x32x16_bf16 v[24:39], v[80:83], v[88:91], v[24:39]
    ds_read_b128 v[76:79], v96 offset:40960
    s_waitcnt lgkmcnt(3)
    v_mfma_f32_32x32x16_bf16 v[8:23], v[60:63], v[56:59], v[8:23]
    ds_read_b128 v[80:83], v93 offset:57344
    ds_read_b128 v[84:87], v96 offset:34816
    v_mfma_f32_32x32x16_bf16 v[24:39], v[56:59], v[64:67], v[24:39]
    ds_read_b128 v[88:91], v96 offset:43008
    s_waitcnt lgkmcnt(3)
    v_mfma_f32_32x32x16_bf16 v[8:23], v[72:75], v[68:71], v[8:23]
    ds_read_b128 v[56:59], v94 offset:57344
    ds_read_b128 v[60:63], v96 offset:36864
    v_mfma_f32_32x32x16_bf16 v[24:39], v[68:71], v[76:79], v[24:39]
    ds_read_b128 v[64:67], v96 offset:45056
    s_waitcnt lgkmcnt(3)
    v_mfma_f32_32x32x16_bf16 v[8:23], v[84:87], v[80:83], v[8:23]
    ds_read_b128 v[68:71], v95 offset:57344
    ds_read_b128 v[72:75], v96 offset:38912
    v_mfma_f32_32x32x16_bf16 v[24:39], v[80:83], v[88:91], v[24:39]
    ds_read_b128 v[76:79], v96 offset:47104
    s_waitcnt lgkmcnt(3)
    s_barrier
    v_mfma_f32_32x32x16_bf16 v[8:23], v[60:63], v[56:59], v[8:23]
    ds_read_b128 v[80:83], v92 offset:0
    ds_read_b128 v[84:87], v96 offset:49152
    v_mfma_f32_32x32x16_bf16 v[24:39], v[56:59], v[64:67], v[24:39]
    s_waitcnt lgkmcnt(2)
    v_mfma_f32_32x32x16_bf16 v[8:23], v[72:75], v[68:71], v[8:23]
    ds_read_b128 v[56:59], v93 offset:0
    ds_read_b128 v[60:63], v96 offset:51200
    v_mfma_f32_32x32x16_bf16 v[24:39], v[68:71], v[76:79], v[24:39]
    s_waitcnt lgkmcnt(2)
    v_mfma_f32_32x32x16_bf16 v[40:55], v[84:87], v[80:83], v[40:55]
    ds_read_b128 v[68:71], v94 offset:0
    ds_read_b128 v[72:75], v96 offset:53248
    s_nop 4
    v_mul_f32 v8, v8, v99
    v_mul_f32 v9, v9, v99
    v_mul_f32 v10, v10, v99
    v_mul_f32 v11, v11, v99
    v_mul_f32 v12, v12, v99
    s_waitcnt lgkmcnt(2)
    v_mfma_f32_32x32x16_bf16 v[40:55], v[60:63], v[56:59], v[40:55]
    ds_read_b128 v[80:83], v95 offset:0
    ds_read_b128 v[84:87], v96 offset:55296
    v_mul_f32 v13, v13, v99
    v_mul_f32 v14, v14, v99
    v_mul_f32 v15, v15, v99
    v_mul_f32 v16, v16, v99
    v_mul_f32 v17, v17, v99
    s_waitcnt lgkmcnt(2)
    v_mfma_f32_32x32x16_bf16 v[40:55], v[72:75], v[68:71], v[40:55]
    ds_read_b128 v[56:59], v92 offset:8192
    ds_read_b128 v[60:63], v96 offset:57344
    v_mul_f32 v18, v18, v99
    v_mul_f32 v19, v19, v99
    v_mul_f32 v20, v20, v99
    v_mul_f32 v21, v21, v99
    v_mul_f32 v22, v22, v99
    s_waitcnt lgkmcnt(2)
    v_mfma_f32_32x32x16_bf16 v[40:55], v[84:87], v[80:83], v[40:55]
    ds_read_b128 v[68:71], v93 offset:8192
    ds_read_b128 v[72:75], v96 offset:59392
    v_mul_f32 v23, v23, v99
    v_cvt_pk_bf16_f32 v142, v8, v9
    v_cvt_pk_bf16_f32 v143, v10, v11
    v_cvt_pk_bf16_f32 v144, v12, v13
    v_cvt_pk_bf16_f32 v145, v14, v15
    s_waitcnt lgkmcnt(2)
    v_mfma_f32_32x32x16_bf16 v[40:55], v[60:63], v[56:59], v[40:55]
    ds_read_b128 v[80:83], v94 offset:8192
    ds_read_b128 v[84:87], v96 offset:61440
    v_cvt_pk_bf16_f32 v146, v16, v17
    v_cvt_pk_bf16_f32 v147, v18, v19
    v_cvt_pk_bf16_f32 v148, v20, v21
    v_cvt_pk_bf16_f32 v149, v22, v23
    buffer_store_dwordx4 v[142:145], v1, s[12:15], s46 offen sc1
    s_waitcnt lgkmcnt(2)
    v_mfma_f32_32x32x16_bf16 v[40:55], v[72:75], v[68:71], v[40:55]
    ds_read_b128 v[56:59], v95 offset:8192
    ds_read_b128 v[60:63], v96 offset:63488
    buffer_store_dwordx4 v[146:149], v1, s[12:15], s47 offen sc1
    v_mul_f32 v24, v24, v126
    v_mul_f32 v25, v25, v127
    v_mul_f32 v26, v26, v128
    v_mul_f32 v27, v27, v129
    s_waitcnt lgkmcnt(2)
    s_barrier
    v_mfma_f32_32x32x16_bf16 v[40:55], v[84:87], v[80:83], v[40:55]
    ds_read_b128 v[68:71], v92 offset:16384
    ds_read_b128 v[72:75], v97 offset:0
    v_mul_f32 v28, v28, v130
    v_mul_f32 v29, v29, v131
    v_mul_f32 v30, v30, v132
    v_mul_f32 v31, v31, v133
    v_mul_f32 v32, v32, v134
    s_waitcnt lgkmcnt(2)
    v_mfma_f32_32x32x16_bf16 v[40:55], v[60:63], v[56:59], v[40:55]
    ds_read_b128 v[80:83], v93 offset:16384
    ds_read_b128 v[84:87], v97 offset:2048
    v_mul_f32 v33, v33, v135
    v_mul_f32 v34, v34, v136
    v_mul_f32 v35, v35, v137
    v_mul_f32 v36, v36, v138
    v_mul_f32 v37, v37, v139
    s_waitcnt lgkmcnt(2)
    v_mfma_f32_32x32x16_bf16 v[40:55], v[72:75], v[68:71], v[40:55]
    ds_read_b128 v[56:59], v94 offset:16384
    ds_read_b128 v[60:63], v97 offset:4096
    v_mul_f32 v38, v38, v140
    v_mul_f32 v39, v39, v141
    v_cvt_pk_bf16_f32 v150, v24, v25
    v_cvt_pk_bf16_f32 v151, v26, v27
    v_cvt_pk_bf16_f32 v152, v28, v29
    s_waitcnt lgkmcnt(2)
    v_mfma_f32_32x32x16_bf16 v[40:55], v[84:87], v[80:83], v[40:55]
    ds_read_b128 v[68:71], v95 offset:16384
    ds_read_b128 v[72:75], v97 offset:6144
    v_cvt_pk_bf16_f32 v153, v30, v31
    v_cvt_pk_bf16_f32 v154, v32, v33
    v_cvt_pk_bf16_f32 v155, v34, v35
    v_cvt_pk_bf16_f32 v156, v36, v37
    v_cvt_pk_bf16_f32 v157, v38, v39
    s_waitcnt lgkmcnt(2)
    v_mfma_f32_32x32x16_bf16 v[40:55], v[60:63], v[56:59], v[40:55]
    ds_read_b128 v[80:83], v92 offset:24576
    ds_read_b128 v[84:87], v97 offset:8192
    buffer_store_dwordx4 v[150:153], v106, s[12:15], s45 offen sc1
    buffer_store_dwordx4 v[154:157], v106, s[12:15], s45 offen offset:256 sc1
    s_waitcnt lgkmcnt(2)
    v_mfma_f32_32x32x16_bf16 v[40:55], v[72:75], v[68:71], v[40:55]
    ds_read_b128 v[56:59], v93 offset:24576
    ds_read_b128 v[60:63], v97 offset:10240
    s_waitcnt lgkmcnt(2)
    v_mfma_f32_32x32x16_bf16 v[40:55], v[84:87], v[80:83], v[40:55]
    ds_read_b128 v[68:71], v94 offset:24576
    ds_read_b128 v[72:75], v97 offset:12288
    s_waitcnt lgkmcnt(2)
    v_mfma_f32_32x32x16_bf16 v[40:55], v[60:63], v[56:59], v[40:55]
    ds_read_b128 v[80:83], v95 offset:24576
    ds_read_b128 v[84:87], v97 offset:14336
    s_waitcnt lgkmcnt(2)
    s_barrier
    v_mfma_f32_32x32x16_bf16 v[40:55], v[72:75], v[68:71], v[40:55]
    ds_read_b128 v[56:59], v92 offset:32768
    ds_read_b128 v[60:63], v96 offset:0
    s_waitcnt lgkmcnt(2)
    v_mfma_f32_32x32x16_bf16 v[40:55], v[84:87], v[80:83], v[40:55]
    ds_read_b128 v[68:71], v93 offset:32768
    ds_read_b128 v[72:75], v96 offset:2048
    s_waitcnt lgkmcnt(2)
    v_mfma_f32_32x32x16_bf16 v[40:55], v[60:63], v[56:59], v[40:55]
    ds_read_b128 v[80:83], v94 offset:32768
    ds_read_b128 v[84:87], v96 offset:4096
    s_waitcnt lgkmcnt(2)
    v_mfma_f32_32x32x16_bf16 v[40:55], v[72:75], v[68:71], v[40:55]
    ds_read_b128 v[56:59], v95 offset:32768
    ds_read_b128 v[60:63], v96 offset:6144
    s_waitcnt lgkmcnt(2)
    v_mfma_f32_32x32x16_bf16 v[40:55], v[84:87], v[80:83], v[40:55]
    ds_read_b128 v[68:71], v92 offset:40960
    ds_read_b128 v[72:75], v96 offset:8192
    s_waitcnt lgkmcnt(2)
    v_mfma_f32_32x32x16_bf16 v[40:55], v[60:63], v[56:59], v[40:55]
    ds_read_b128 v[80:83], v93 offset:40960
    ds_read_b128 v[84:87], v96 offset:10240
    s_waitcnt lgkmcnt(2)
    s_lshl_b32 s40, s22, 3
    s_add_u32 s40, s40, s23
    v_lshlrev_b32 v2, 3, v0
    v_add_u32 v2, s40, v2
    s_movk_i32 s41, 0x100
    v_cmp_gt_u32 s[42:43], s41, v2
    v_lshlrev_b32 v2, 7, v2
    v_mov_b32 v3, 1
    s_add_u32 s40, s17, 0
    s_and_b32 s42, s42, 0x1f
    s_mov_b32 s43, 0
    s_waitcnt vmcnt(0)
    s_mov_b64 exec, s[42:43]
    buffer_atomic_add v3, v2, s[12:15], s40 offen sc1
    s_mov_b64 exec, -1
mega_kernel_sg22:
    v_mfma_f32_32x32x16_bf16 v[40:55], v[72:75], v[68:71], v[40:55]
    ds_read_b128 v[56:59], v94 offset:40960
    ds_read_b128 v[60:63], v96 offset:12288
    s_waitcnt lgkmcnt(2)
    v_mfma_f32_32x32x16_bf16 v[40:55], v[84:87], v[80:83], v[40:55]
    ds_read_b128 v[68:71], v95 offset:40960
    ds_read_b128 v[72:75], v96 offset:14336
    s_waitcnt lgkmcnt(2)
    s_barrier
    v_mfma_f32_32x32x16_bf16 v[40:55], v[60:63], v[56:59], v[40:55]
    ds_read_b128 v[80:83], v92 offset:49152
    ds_read_b128 v[84:87], v96 offset:16384
    s_waitcnt lgkmcnt(2)
    v_mfma_f32_32x32x16_bf16 v[40:55], v[72:75], v[68:71], v[40:55]
    ds_read_b128 v[56:59], v93 offset:49152
    ds_read_b128 v[60:63], v96 offset:18432
    s_waitcnt lgkmcnt(2)
    v_mfma_f32_32x32x16_bf16 v[40:55], v[84:87], v[80:83], v[40:55]
    ds_read_b128 v[68:71], v94 offset:49152
    ds_read_b128 v[72:75], v96 offset:20480
    s_waitcnt lgkmcnt(2)
    v_mfma_f32_32x32x16_bf16 v[40:55], v[60:63], v[56:59], v[40:55]
    ds_read_b128 v[80:83], v95 offset:49152
    ds_read_b128 v[84:87], v96 offset:22528
    s_waitcnt lgkmcnt(2)
    v_mfma_f32_32x32x16_bf16 v[40:55], v[72:75], v[68:71], v[40:55]
    ds_read_b128 v[56:59], v92 offset:57344
    ds_read_b128 v[60:63], v96 offset:24576
    s_waitcnt lgkmcnt(2)
    v_mfma_f32_32x32x16_bf16 v[40:55], v[84:87], v[80:83], v[40:55]
    ds_read_b128 v[68:71], v93 offset:57344
    ds_read_b128 v[72:75], v96 offset:26624
    s_waitcnt lgkmcnt(2)
    v_mfma_f32_32x32x16_bf16 v[40:55], v[60:63], v[56:59], v[40:55]
    ds_read_b128 v[80:83], v94 offset:57344
    ds_read_b128 v[84:87], v96 offset:28672
    s_waitcnt lgkmcnt(2)
    v_mfma_f32_32x32x16_bf16 v[40:55], v[72:75], v[68:71], v[40:55]
    ds_read_b128 v[56:59], v95 offset:57344
    ds_read_b128 v[60:63], v96 offset:30720
    s_waitcnt lgkmcnt(2)
    v_mfma_f32_32x32x16_bf16 v[40:55], v[84:87], v[80:83], v[40:55]
    s_waitcnt lgkmcnt(0)
    v_mfma_f32_32x32x16_bf16 v[40:55], v[60:63], v[56:59], v[40:55]
    s_nop 11
    v_mul_f32 v40, v40, v101
    v_mul_f32 v41, v41, v101
    v_mul_f32 v42, v42, v101
    v_mul_f32 v43, v43, v101
    v_mul_f32 v44, v44, v101
    v_mul_f32 v45, v45, v101
    v_mul_f32 v46, v46, v101
    v_mul_f32 v47, v47, v101
    v_mul_f32 v48, v48, v101
    v_mul_f32 v49, v49, v101
    v_mul_f32 v50, v50, v101
    v_mul_f32 v51, v51, v101
    v_mul_f32 v52, v52, v101
    v_mul_f32 v53, v53, v101
    v_mul_f32 v54, v54, v101
    v_mul_f32 v55, v55, v101
    v_cvt_pk_bf16_f32 v126, v40, v41
    v_cvt_pk_bf16_f32 v127, v42, v43
    v_cvt_pk_bf16_f32 v128, v44, v45
    v_cvt_pk_bf16_f32 v129, v46, v47
    v_cvt_pk_bf16_f32 v130, v48, v49
    v_cvt_pk_bf16_f32 v131, v50, v51
    v_cvt_pk_bf16_f32 v132, v52, v53
    v_cvt_pk_bf16_f32 v133, v54, v55
    ds_write_b128 v109, v[126:129]
    ds_write_b128 v109, v[130:133] offset:2048
    s_waitcnt lgkmcnt(0)
    s_barrier
    s_branch mega_kernel_p1end19
mega_kernel_p1h18:
    s_barrier
    s_barrier
    s_barrier
    s_barrier
    s_barrier
    s_barrier
    s_barrier
    s_barrier
    s_barrier
    s_barrier
    s_barrier
    s_barrier
    s_barrier
mega_kernel_p1end19:
    s_and_b32 s35, s19, 1
    s_lshr_b32 s36, s19, 1
    s_lshl_b32 s32, s22, 1
    s_add_u32 s32, s32, s35
    s_mul_i32 s37, s36, 10240
    s_lshl_b32 s38, s35, 10
    s_add_u32 s37, s37, s38
    v_add_u32 v131, s37, v1
    s_lshl_b32 s38, s19, 10
    s_add_u32 s38, s38, 114688
    v_add_u32 v2, s38, v1
    ds_read_b128 v[8:11], v2
    v_mov_b32 v48, 0x3f803f80
    v_mov_b32 v49, 0x3f803f80
    v_mov_b32 v50, 0x3f803f80
    v_mov_b32 v51, 0x3f803f80
    v_and_b32 v2, 0x1f0, v1
    v_add_u32 v2, 162304, v2
    ds_write_b128 v2, v[48:51]
    v_lshrrev_b32 v3, 5, v0
    v_and_b32 v2, 15, v0
    v_lshlrev_b32 v2, 4, v2
    v_lshl_add_u32 v2, v3, 9, v2
    s_add_u32 s37, s37, 40960
    v_add_u32 v2, s37, v2
    v_and_b32 v4, 16, v0
    v_cmp_eq_u32 s[44:45], 0, v4
    v_mov_b32 v4, 162304
    s_nop 0
    v_cndmask_b32 v133, v4, v2, s[44:45]
    v_mov_b32 v4, 0x400
    v_cndmask_b32 v134, 0, v4, s[44:45]
    v_and_b32 v2, 31, v0
    v_lshlrev_b32 v3, 2, v3
    v_sub_u32 v132, v2, v3
    v_mov_b32 v129, 0xffff
    v_mov_b32 v130, 0xffff0000
    v_cmp_le_i32 s[44:45], 0, v132
    v_cmp_le_i32 s[46:47], 1, v132
    s_nop 0
    v_cndmask_b32 v2, 0, v129, s[44:45]
    v_cndmask_b32 v3, 0, v130, s[46:47]
    v_or_b32 v16, v2, v3
    v_cmp_le_i32 s[44:45], 2, v132
    v_cmp_le_i32 s[46:47], 3, v132
    s_nop 0
    v_cndmask_b32 v2, 0, v129, s[44:45]
    v_cndmask_b32 v3, 0, v130, s[46:47]
    v_or_b32 v17, v2, v3
    v_cmp_le_i32 s[44:45], 8, v132
    v_cmp_le_i32 s[46:47], 9, v132
    s_nop 0
    v_cndmask_b32 v2, 0, v129, s[44:45]
    v_cndmask_b32 v3, 0, v130, s[46:47]
    v_or_b32 v18, v2, v3
    v_cmp_le_i32 s[44:45], 10, v132
    v_cmp_le_i32 s[46:47], 11, v132
    s_nop 0
    v_cndmask_b32 v2, 0, v129, s[44:45]
    v_cndmask_b32 v3, 0, v130, s[46:47]
    v_or_b32 v19, v2, v3
    v_cmp_le_i32 s[44:45], 16, v132
    v_cmp_le_i32 s[46:47], 17, v132
    s_nop 0
    v_cndmask_b32 v2, 0, v129, s[44:45]
    v_cndmask_b32 v3, 0, v130, s[46:47]
    v_or_b32 v20, v2, v3
    v_cmp_le_i32 s[44:45], 18, v132
    v_cmp_le_i32 s[46:47], 19, v132
    s_nop 0
    v_cndmask_b32 v2, 0, v129, s[44:45]
    v_cndmask_b32 v3, 0, v130, s[46:47]
    v_or_b32 v21, v2, v3
    v_cmp_le_i32 s[44:45], 24, v132
    v_cmp_le_i32 s[46:47], 25, v132
    s_nop 0
    v_cndmask_b32 v2, 0, v129, s[44:45]
    v_cndmask_b32 v3, 0, v130, s[46:47]
    v_or_b32 v22, v2, v3
    v_cmp_le_i32 s[44:45], 26, v132
    v_cmp_le_i32 s[46:47], 27, v132
    s_nop 0
    v_cndmask_b32 v2, 0, v129, s[44:45]
    v_cndmask_b32 v3, 0, v130, s[46:47]
    v_or_b32 v23, v2, v3
    s_waitcnt lgkmcnt(0)
    s_barrier
    ds_read_b128 v[24:27], v131 offset:8192
    ds_read_b128 v[28:31], v131 offset:0
    s_waitcnt lgkmcnt(1)
    v_mfma_f32_32x32x16_bf16 v[48:63], v[24:27], v[8:11], 0
    s_waitcnt lgkmcnt(0)
    v_mfma_f32_32x32x16_bf16 v[80:95], v[28:31], v[8:11], 0
    ds_read_b128 v[24:27], v131 offset:7168
    ds_read_b128 v[28:31], v131 offset:6144
    s_waitcnt lgkmcnt(1)
    v_mfma_f32_32x32x16_bf16 v[64:79], v[24:27], v[8:11], 0
    s_nop 7
    s_cmp_ge_u32 s32, 8
    s_cbranch_scc1 mega_kernel_p2v036
    v_mov_b32 v80, 0xff800000
    v_mov_b32 v81, 0xff800000
    v_mov_b32 v82, 0xff800000
    v_mov_b32 v83, 0xff800000
    v_mov_b32 v84, 0xff800000
    v_mov_b32 v85, 0xff800000
    v_mov_b32 v86, 0xff800000
    v_mov_b32 v87, 0xff800000
    v_mov_b32 v88, 0xff800000
    v_mov_b32 v89, 0xff800000
    v_mov_b32 v90, 0xff800000
    v_mov_b32 v91, 0xff800000
    v_mov_b32 v92, 0xff800000
    v_mov_b32 v93, 0xff800000
    v_mov_b32 v94, 0xff800000
    v_mov_b32 v95, 0xff800000
mega_kernel_p2v036:
    s_nop 3
    v_cmp_le_i32 s[44:45], 0, v132
    v_cmp_le_i32 s[46:47], 1, v132
    v_cmp_le_i32 s[48:49], 2, v132
    v_cmp_le_i32 s[50:51], 3, v132
    v_cndmask_b32 v48, v80, v48, s[44:45]
    v_cndmask_b32 v49, v81, v49, s[46:47]
    v_cndmask_b32 v50, v82, v50, s[48:49]
    v_cndmask_b32 v51, v83, v51, s[50:51]
    v_cmp_le_i32 s[44:45], 8, v132
    v_cmp_le_i32 s[46:47], 9, v132
    v_cmp_le_i32 s[48:49], 10, v132
    v_cmp_le_i32 s[50:51], 11, v132
    v_cndmask_b32 v52, v84, v52, s[44:45]
    v_cndmask_b32 v53, v85, v53, s[46:47]
    v_cndmask_b32 v54, v86, v54, s[48:49]
    v_cndmask_b32 v55, v87, v55, s[50:51]
    v_cmp_le_i32 s[44:45], 16, v132
    v_cmp_le_i32 s[46:47], 17, v132
    v_cmp_le_i32 s[48:49], 18, v132
    v_cmp_le_i32 s[50:51], 19, v132
    v_cndmask_b32 v56, v88, v56, s[44:45]
    v_cndmask_b32 v57, v89, v57, s[46:47]
    v_cndmask_b32 v58, v90, v58, s[48:49]
    v_cndmask_b32 v59, v91, v59, s[50:51]
    v_cmp_le_i32 s[44:45], 24, v132
    v_cmp_le_i32 s[46:47], 25, v132
    v_cmp_le_i32 s[48:49], 26, v132
    v_cmp_le_i32 s[50:51], 27, v132
    v_cndmask_b32 v60, v92, v60, s[44:45]
    v_cndmask_b32 v61, v93, v61, s[46:47]
    v_cndmask_b32 v62, v94, v62, s[48:49]
    v_cndmask_b32 v63, v95, v63, s[50:51]
    v_max3_f32 v128, v48, v49, v50
    v_max3_f32 v129, v51, v52, v53
    v_max3_f32 v128, v128, v54, v55
    v_max3_f32 v129, v129, v56, v57
    v_max3_f32 v128, v128, v58, v59
    v_max3_f32 v129, v129, v60, v61
    v_max3_f32 v128, v128, v62, v63
    s_cmp_lt_u32 s32, 1
    s_cbranch_scc1 mega_kernel_p2m37
    s_waitcnt lgkmcnt(0)
    v_mfma_f32_32x32x16_bf16 v[80:95], v[28:31], v[8:11], 0
    ds_read_b128 v[24:27], v131 offset:5120
    v_max3_f32 v128, v128, v64, v65
    v_max3_f32 v129, v129, v66, v67
    v_max3_f32 v128, v128, v68, v69
    v_max3_f32 v129, v129, v70, v71
    v_max3_f32 v128, v128, v72, v73
    v_max3_f32 v129, v129, v74, v75
    v_max3_f32 v128, v128, v76, v77
    v_max3_f32 v129, v129, v78, v79
    s_cmp_lt_u32 s32, 2
    s_cbranch_scc1 mega_kernel_p2m37
    s_waitcnt lgkmcnt(0)
    v_mfma_f32_32x32x16_bf16 v[64:79], v[24:27], v[8:11], 0
    ds_read_b128 v[28:31], v131 offset:4096
    v_max3_f32 v128, v128, v80, v81
    v_max3_f32 v129, v129, v82, v83
    v_max3_f32 v128, v128, v84, v85
    v_max3_f32 v129, v129, v86, v87
    v_max3_f32 v128, v128, v88, v89
    v_max3_f32 v129, v129, v90, v91
    v_max3_f32 v128, v128, v92, v93
    v_max3_f32 v129, v129, v94, v95
    s_cmp_lt_u32 s32, 3
    s_cbranch_scc1 mega_kernel_p2m37
    s_waitcnt lgkmcnt(0)
    v_mfma_f32_32x32x16_bf16 v[80:95], v[28:31], v[8:11], 0
    ds_read_b128 v[24:27], v131 offset:3072
    v_max3_f32 v128, v128, v64, v65
    v_max3_f32 v129, v129, v66, v67
    v_max3_f32 v128, v128, v68, v69
    v_max3_f32 v129, v129, v70, v71
    v_max3_f32 v128, v128, v72, v73
    v_max3_f32 v129, v129, v74, v75
    v_max3_f32 v128, v128, v76, v77
    v_max3_f32 v129, v129, v78, v79
    s_cmp_lt_u32 s32, 4
    s_cbranch_scc1 mega_kernel_p2m37
    s_waitcnt lgkmcnt(0)
    v_mfma_f32_32x32x16_bf16 v[64:79], v[24:27], v[8:11], 0
    ds_read_b128 v[28:31], v131 offset:2048
    v_max3_f32 v128, v128, v80, v81
    v_max3_f32 v129, v129, v82, v83
    v_max3_f32 v128, v128, v84, v85
    v_max3_f32 v129, v129, v86, v87
    v_max3_f32 v128, v128, v88, v89
    v_max3_f32 v129, v129, v90, v91
    v_max3_f32 v128, v128, v92, v93
    v_max3_f32 v129, v129, v94, v95
    s_cmp_lt_u32 s32, 5
    s_cbranch_scc1 mega_kernel_p2m37
    s_waitcnt lgkmcnt(0)
    v_mfma_f32_32x32x16_bf16 v[80:95], v[28:31], v[8:11], 0
    ds_read_b128 v[24:27], v131 offset:1024
    v_max3_f32 v128, v128, v64, v65
    v_max3_f32 v129, v129, v66, v67
    v_max3_f32 v128, v128, v68, v69
    v_max3_f32 v129, v129, v70, v71
    v_max3_f32 v128, v128, v72, v73
    v_max3_f32 v129, v129, v74, v75
    v_max3_f32 v128, v128, v76, v77
    v_max3_f32 v129, v129, v78, v79
    s_cmp_lt_u32 s32, 6
    s_cbranch_scc1 mega_kernel_p2m37
    s_waitcnt lgkmcnt(0)
    v_mfma_f32_32x32x16_bf16 v[64:79], v[24:27], v[8:11], 0
    v_max3_f32 v128, v128, v80, v81
    v_max3_f32 v129, v129, v82, v83
    v_max3_f32 v128, v128, v84, v85
    v_max3_f32 v129, v129, v86, v87
    v_max3_f32 v128, v128, v88, v89
    v_max3_f32 v129, v129, v90, v91
    v_max3_f32 v128, v128, v92, v93
    v_max3_f32 v129, v129, v94, v95
    s_cmp_lt_u32 s32, 7
    s_cbranch_scc1 mega_kernel_p2m37
    s_nop 1
    v_max3_f32 v128, v128, v64, v65
    v_max3_f32 v129, v129, v66, v67
    v_max3_f32 v128, v128, v68, v69
    v_max3_f32 v129, v129, v70, v71
    v_max3_f32 v128, v128, v72, v73
    v_max3_f32 v129, v129, v74, v75
    v_max3_f32 v128, v128, v76, v77
    v_max3_f32 v129, v129, v78, v79
mega_kernel_p2m37:
    s_nop 15
    s_waitcnt lgkmcnt(0)
    s_barrier
    ds_read_b128 v[24:27], v131 offset:7168
    ds_read_b128 v[28:31], v131 offset:6144
    v_mad_u32_u24 v135, v134, 8, v133
    ds_read_b128 v[32:35], v135
    ds_read_b128 v[36:39], v135 offset:256
    v_mad_u32_u24 v135, v134, 0, v133
    ds_read_b128 v[40:43], v135
    ds_read_b128 v[44:47], v135 offset:256
    v_max_f32 v128, v128, v129
    v_mov_b32 v129, v128
    s_nop 1
    v_permlane32_swap_b32 v129, v128
    v_max_f32 v128, v128, v129
    v_sub_f32 v96, 0, v128
    v_mov_b32 v97, v96
    v_mov_b32 v98, v96
    v_mov_b32 v99, v96
    v_mov_b32 v100, v96
    v_mov_b32 v101, v96
    v_mov_b32 v102, v96
    v_mov_b32 v103, v96
    v_mov_b32 v104, v96
    v_mov_b32 v105, v96
    v_mov_b32 v106, v96
    v_mov_b32 v107, v96
    v_mov_b32 v108, v96
    v_mov_b32 v109, v96
    v_mov_b32 v110, v96
    v_mov_b32 v111, v96
    s_waitcnt lgkmcnt(5)
    s_nop 0
    v_mfma_f32_32x32x16_bf16 v[64:79], v[24:27], v[8:11], v[96:111]
    v_add_f32 v48, v48, v96
    v_add_f32 v49, v49, v96
    v_add_f32 v50, v50, v96
    v_add_f32 v51, v51, v96
    v_add_f32 v52, v52, v96
    v_add_f32 v53, v53, v96
    v_add_f32 v54, v54, v96
    v_add_f32 v55, v55, v96
    v_add_f32 v56, v56, v96
    v_add_f32 v57, v57, v96
    v_add_f32 v58, v58, v96
    v_add_f32 v59, v59, v96
    v_add_f32 v60, v60, v96
    v_add_f32 v61, v61, v96
    v_add_f32 v62, v62, v96
    v_add_f32 v63, v63, v96
    v_exp_f32 v48, v48
    v_exp_f32 v49, v49
    v_exp_f32 v50, v50
    v_exp_f32 v51, v51
    v_exp_f32 v52, v52
    v_exp_f32 v53, v53
    v_exp_f32 v54, v54
    v_exp_f32 v55, v55
    v_exp_f32 v56, v56
    v_exp_f32 v57, v57
    v_exp_f32 v58, v58
    v_exp_f32 v59, v59
    v_exp_f32 v60, v60
    v_exp_f32 v61, v61
    v_exp_f32 v62, v62
    v_exp_f32 v63, v63
    v_cvt_pk_bf16_f32 v48, v48, v49
    v_cvt_pk_bf16_f32 v49, v50, v51
    v_cvt_pk_bf16_f32 v50, v52, v53
    v_cvt_pk_bf16_f32 v51, v54, v55
    v_cvt_pk_bf16_f32 v52, v56, v57
    v_cvt_pk_bf16_f32 v53, v58, v59
    v_cvt_pk_bf16_f32 v54, v60, v61
    v_cvt_pk_bf16_f32 v55, v62, v63
    v_and_b32 v56, v48, v16
    v_and_b32 v57, v49, v17
    v_and_b32 v58, v50, v18
    v_and_b32 v59, v51, v19
    v_and_b32 v60, v52, v20
    v_and_b32 v61, v53, v21
    v_and_b32 v62, v54, v22
    v_and_b32 v63, v55, v23
    s_waitcnt lgkmcnt(0)
    v_mfma_f32_32x32x16_bf16 v[112:127], v[32:35], v[56:59], 0
    v_mfma_f32_32x32x16_bf16 v[112:127], v[36:39], v[60:63], v[112:127]
    v_xor_b32 v48, v48, v56
    v_xor_b32 v49, v49, v57
    v_xor_b32 v50, v50, v58
    v_xor_b32 v51, v51, v59
    v_xor_b32 v52, v52, v60
    v_xor_b32 v53, v53, v61
    v_xor_b32 v54, v54, v62
    v_xor_b32 v55, v55, v63
    v_mfma_f32_32x32x16_bf16 v[112:127], v[40:43], v[48:51], v[112:127]
    s_nop 0
    v_mfma_f32_32x32x16_bf16 v[112:127], v[44:47], v[52:55], v[112:127]
    v_mad_u32_u24 v135, v134, 7, v133
    ds_read_b128 v[32:35], v135
    ds_read_b128 v[36:39], v135 offset:256
    s_cmp_lt_u32 s32, 1
    s_cbranch_scc1 mega_kernel_p2e38
    v_mfma_f32_32x32x16_bf16 v[80:95], v[28:31], v[8:11], v[96:111]
    ds_read_b128 v[24:27], v131 offset:5120
    v_mad_u32_u24 v135, v134, 6, v133
    ds_read_b128 v[40:43], v135
    ds_read_b128 v[44:47], v135 offset:256
    v_exp_f32 v64, v64
    v_exp_f32 v65, v65
    v_exp_f32 v66, v66
    v_exp_f32 v67, v67
    v_exp_f32 v68, v68
    v_exp_f32 v69, v69
    v_exp_f32 v70, v70
    v_exp_f32 v71, v71
    v_exp_f32 v72, v72
    v_exp_f32 v73, v73
    v_exp_f32 v74, v74
    v_exp_f32 v75, v75
    v_exp_f32 v76, v76
    v_exp_f32 v77, v77
    v_exp_f32 v78, v78
    v_exp_f32 v79, v79
    v_cvt_pk_bf16_f32 v64, v64, v65
    v_cvt_pk_bf16_f32 v65, v66, v67
    v_cvt_pk_bf16_f32 v66, v68, v69
    v_cvt_pk_bf16_f32 v67, v70, v71
    v_cvt_pk_bf16_f32 v68, v72, v73
    v_cvt_pk_bf16_f32 v69, v74, v75
    v_cvt_pk_bf16_f32 v70, v76, v77
    v_cvt_pk_bf16_f32 v71, v78, v79
    s_waitcnt lgkmcnt(0)
    v_mfma_f32_32x32x16_bf16 v[112:127], v[32:35], v[64:67], v[112:127]
    v_mfma_f32_32x32x16_bf16 v[112:127], v[36:39], v[68:71], v[112:127]
    s_cmp_lt_u32 s32, 2
    s_cbranch_scc1 mega_kernel_p2e38
    v_mfma_f32_32x32x16_bf16 v[64:79], v[24:27], v[8:11], v[96:111]
    ds_read_b128 v[28:31], v131 offset:4096
    v_mad_u32_u24 v135, v134, 5, v133
    ds_read_b128 v[32:35], v135
    ds_read_b128 v[36:39], v135 offset:256
    v_exp_f32 v80, v80
    v_exp_f32 v81, v81
    v_exp_f32 v82, v82
    v_exp_f32 v83, v83
    v_exp_f32 v84, v84
    v_exp_f32 v85, v85
    v_exp_f32 v86, v86
    v_exp_f32 v87, v87
    v_exp_f32 v88, v88
    v_exp_f32 v89, v89
    v_exp_f32 v90, v90
    v_exp_f32 v91, v91
    v_exp_f32 v92, v92
    v_exp_f32 v93, v93
    v_exp_f32 v94, v94
    v_exp_f32 v95, v95
    v_cvt_pk_bf16_f32 v80, v80, v81
    v_cvt_pk_bf16_f32 v81, v82, v83
    v_cvt_pk_bf16_f32 v82, v84, v85
    v_cvt_pk_bf16_f32 v83, v86, v87
    v_cvt_pk_bf16_f32 v84, v88, v89
    v_cvt_pk_bf16_f32 v85, v90, v91
    v_cvt_pk_bf16_f32 v86, v92, v93
    v_cvt_pk_bf16_f32 v87, v94, v95
    s_waitcnt lgkmcnt(0)
    v_mfma_f32_32x32x16_bf16 v[112:127], v[40:43], v[80:83], v[112:127]
    v_mfma_f32_32x32x16_bf16 v[112:127], v[44:47], v[84:87], v[112:127]
    s_cmp_lt_u32 s32, 3
    s_cbranch_scc1 mega_kernel_p2e38
    v_mfma_f32_32x32x16_bf16 v[80:95], v[28:31], v[8:11], v[96:111]
    ds_read_b128 v[24:27], v131 offset:3072
    v_mad_u32_u24 v135, v134, 4, v133
    ds_read_b128 v[40:43], v135
    ds_read_b128 v[44:47], v135 offset:256
    v_exp_f32 v64, v64
    v_exp_f32 v65, v65
    v_exp_f32 v66, v66
    v_exp_f32 v67, v67
    v_exp_f32 v68, v68
    v_exp_f32 v69, v69
    v_exp_f32 v70, v70
    v_exp_f32 v71, v71
    v_exp_f32 v72, v72
    v_exp_f32 v73, v73
    v_exp_f32 v74, v74
    v_exp_f32 v75, v75
    v_exp_f32 v76, v76
    v_exp_f32 v77, v77
    v_exp_f32 v78, v78
    v_exp_f32 v79, v79
    v_cvt_pk_bf16_f32 v64, v64, v65
    v_cvt_pk_bf16_f32 v65, v66, v67
    v_cvt_pk_bf16_f32 v66, v68, v69
    v_cvt_pk_bf16_f32 v67, v70, v71
    v_cvt_pk_bf16_f32 v68, v72, v73
    v_cvt_pk_bf16_f32 v69, v74, v75
    v_cvt_pk_bf16_f32 v70, v76, v77
    v_cvt_pk_bf16_f32 v71, v78, v79
    s_waitcnt lgkmcnt(0)
    v_mfma_f32_32x32x16_bf16 v[112:127], v[32:35], v[64:67], v[112:127]
    v_mfma_f32_32x32x16_bf16 v[112:127], v[36:39], v[68:71], v[112:127]
    s_cmp_lt_u32 s32, 4
    s_cbranch_scc1 mega_kernel_p2e38
    v_mfma_f32_32x32x16_bf16 v[64:79], v[24:27], v[8:11], v[96:111]
    ds_read_b128 v[28:31], v131 offset:2048
    v_mad_u32_u24 v135, v134, 3, v133
    ds_read_b128 v[32:35], v135
    ds_read_b128 v[36:39], v135 offset:256
    v_exp_f32 v80, v80
    v_exp_f32 v81, v81
    v_exp_f32 v82, v82
    v_exp_f32 v83, v83
    v_exp_f32 v84, v84
    v_exp_f32 v85, v85
    v_exp_f32 v86, v86
    v_exp_f32 v87, v87
    v_exp_f32 v88, v88
    v_exp_f32 v89, v89
    v_exp_f32 v90, v90
    v_exp_f32 v91, v91
    v_exp_f32 v92, v92
    v_exp_f32 v93, v93
    v_exp_f32 v94, v94
    v_exp_f32 v95, v95
    v_cvt_pk_bf16_f32 v80, v80, v81
    v_cvt_pk_bf16_f32 v81, v82, v83
    v_cvt_pk_bf16_f32 v82, v84, v85
    v_cvt_pk_bf16_f32 v83, v86, v87
    v_cvt_pk_bf16_f32 v84, v88, v89
    v_cvt_pk_bf16_f32 v85, v90, v91
    v_cvt_pk_bf16_f32 v86, v92, v93
    v_cvt_pk_bf16_f32 v87, v94, v95
    s_waitcnt lgkmcnt(0)
    v_mfma_f32_32x32x16_bf16 v[112:127], v[40:43], v[80:83], v[112:127]
    v_mfma_f32_32x32x16_bf16 v[112:127], v[44:47], v[84:87], v[112:127]
    s_cmp_lt_u32 s32, 5
    s_cbranch_scc1 mega_kernel_p2e38
    v_mfma_f32_32x32x16_bf16 v[80:95], v[28:31], v[8:11], v[96:111]
    ds_read_b128 v[24:27], v131 offset:1024
    v_mad_u32_u24 v135, v134, 2, v133
    ds_read_b128 v[40:43], v135
    ds_read_b128 v[44:47], v135 offset:256
    v_exp_f32 v64, v64
    v_exp_f32 v65, v65
    v_exp_f32 v66, v66
    v_exp_f32 v67, v67
    v_exp_f32 v68, v68
    v_exp_f32 v69, v69
    v_exp_f32 v70, v70
    v_exp_f32 v71, v71
    v_exp_f32 v72, v72
    v_exp_f32 v73, v73
    v_exp_f32 v74, v74
    v_exp_f32 v75, v75
    v_exp_f32 v76, v76
    v_exp_f32 v77, v77
    v_exp_f32 v78, v78
    v_exp_f32 v79, v79
    v_cvt_pk_bf16_f32 v64, v64, v65
    v_cvt_pk_bf16_f32 v65, v66, v67
    v_cvt_pk_bf16_f32 v66, v68, v69
    v_cvt_pk_bf16_f32 v67, v70, v71
    v_cvt_pk_bf16_f32 v68, v72, v73
    v_cvt_pk_bf16_f32 v69, v74, v75
    v_cvt_pk_bf16_f32 v70, v76, v77
    v_cvt_pk_bf16_f32 v71, v78, v79
    s_waitcnt lgkmcnt(0)
    v_mfma_f32_32x32x16_bf16 v[112:127], v[32:35], v[64:67], v[112:127]
    v_mfma_f32_32x32x16_bf16 v[112:127], v[36:39], v[68:71], v[112:127]
    s_cmp_lt_u32 s32, 6
    s_cbranch_scc1 mega_kernel_p2e38
    v_mfma_f32_32x32x16_bf16 v[64:79], v[24:27], v[8:11], v[96:111]
    v_mad_u32_u24 v135, v134, 1, v133
    ds_read_b128 v[32:35], v135
    ds_read_b128 v[36:39], v135 offset:256
    v_exp_f32 v80, v80
    v_exp_f32 v81, v81
    v_exp_f32 v82, v82
    v_exp_f32 v83, v83
    v_exp_f32 v84, v84
    v_exp_f32 v85, v85
    v_exp_f32 v86, v86
    v_exp_f32 v87, v87
    v_exp_f32 v88, v88
    v_exp_f32 v89, v89
    v_exp_f32 v90, v90
    v_exp_f32 v91, v91
    v_exp_f32 v92, v92
    v_exp_f32 v93, v93
    v_exp_f32 v94, v94
    v_exp_f32 v95, v95
    v_cvt_pk_bf16_f32 v80, v80, v81
    v_cvt_pk_bf16_f32 v81, v82, v83
    v_cvt_pk_bf16_f32 v82, v84, v85
    v_cvt_pk_bf16_f32 v83, v86, v87
    v_cvt_pk_bf16_f32 v84, v88, v89
    v_cvt_pk_bf16_f32 v85, v90, v91
    v_cvt_pk_bf16_f32 v86, v92, v93
    v_cvt_pk_bf16_f32 v87, v94, v95
    s_waitcnt lgkmcnt(0)
    v_mfma_f32_32x32x16_bf16 v[112:127], v[40:43], v[80:83], v[112:127]
    v_mfma_f32_32x32x16_bf16 v[112:127], v[44:47], v[84:87], v[112:127]
    s_cmp_lt_u32 s32, 7
    s_cbranch_scc1 mega_kernel_p2e38
    v_exp_f32 v64, v64
    v_exp_f32 v65, v65
    v_exp_f32 v66, v66
    v_exp_f32 v67, v67
    v_exp_f32 v68, v68
    v_exp_f32 v69, v69
    v_exp_f32 v70, v70
    v_exp_f32 v71, v71
    v_exp_f32 v72, v72
    v_exp_f32 v73, v73
    v_exp_f32 v74, v74
    v_exp_f32 v75, v75
    v_exp_f32 v76, v76
    v_exp_f32 v77, v77
    v_exp_f32 v78, v78
    v_exp_f32 v79, v79
    v_cvt_pk_bf16_f32 v64, v64, v65
    v_cvt_pk_bf16_f32 v65, v66, v67
    v_cvt_pk_bf16_f32 v66, v68, v69
    v_cvt_pk_bf16_f32 v67, v70, v71
    v_cvt_pk_bf16_f32 v68, v72, v73
    v_cvt_pk_bf16_f32 v69, v74, v75
    v_cvt_pk_bf16_f32 v70, v76, v77
    v_cvt_pk_bf16_f32 v71, v78, v79
    s_waitcnt lgkmcnt(0)
    v_mfma_f32_32x32x16_bf16 v[112:127], v[32:35], v[64:67], v[112:127]
    v_mfma_f32_32x32x16_bf16 v[112:127], v[36:39], v[68:71], v[112:127]
mega_kernel_p2e38:
    s_lshl_b32 s34, s32, 15
    s_lshl_b32 s35, s23, 2
    s_add_u32 s35, s35, s36
    s_lshl_b32 s35, s35, 10
    s_add_u32 s34, s34, s35
    s_add_u32 s34, s34, 6291456
    s_add_u32 s34, s34, s16
    s_nop 15
    s_waitcnt lgkmcnt(0)
    v_rcp_f32 v129, v120
    s_nop 0
    v_mul_f32 v48, v112, v129
    v_mul_f32 v49, v113, v129
    v_mul_f32 v50, v114, v129
    v_mul_f32 v51, v115, v129
    v_mul_f32 v52, v116, v129
    v_mul_f32 v53, v117, v129
    v_mul_f32 v54, v118, v129
    v_mul_f32 v55, v119, v129
    v_cvt_pk_bf16_f32 v56, v48, v49
    v_cvt_pk_bf16_f32 v57, v50, v51
    v_cvt_pk_bf16_f32 v58, v52, v53
    v_cvt_pk_bf16_f32 v59, v54, v55
    buffer_store_dwordx4 v[56:59], v1, s[12:15], s34 offen sc1
    s_lshl_b32 s40, s22, 3
    v_add_u32 v2, s40, v0
    s_movk_i32 s41, 0x100
    v_cmp_gt_u32 s[42:43], s41, v2
    v_lshlrev_b32 v2, 7, v2
    v_mov_b32 v3, 1
    s_add_u32 s40, s17, 32768
    s_and_b32 s42, s42, 0xff
    s_mov_b32 s43, 0
    s_waitcnt vmcnt(0)
    s_barrier
    s_cmp_lg_u32 s19, 0
    s_cbranch_scc1 mega_kernel_sg39
    s_mov_b64 exec, s[42:43]
    buffer_atomic_add v3, v2, s[12:15], s40 offen sc1
    s_mov_b64 exec, -1
mega_kernel_sg39:
    s_cmp_ge_u32 s19, 4
    s_cbranch_scc1 mega_kernel_p3idle50
    s_and_b32 s35, s19, 1
    s_lshr_b32 s36, s19, 1
    s_lshl_b32 s37, s20, 1
    s_add_u32 s37, s37, s35
    s_lshl_b32 s38, s35, 13
    v_add_u32 v98, s38, v1
    s_lshl_b32 s39, s36, 10
    v_add_u32 v101, s39, v1
    v_add_u32 v99, 65536, v98
    v_add_u32 v102, 65536, v101
    v_add_u32 v100, 131072, v98
    v_add_u32 v103, 131072, v101
    s_lshl_b32 s44, s37, 15
    s_lshl_b32 s39, s21, 12
    s_add_u32 s44, s44, s39
    s_lshl_b32 s39, s36, 11
    s_add_u32 s44, s44, s39
    s_add_u32 s44, s44, s16
    s_add_u32 s45, s44, 8388608
    s_add_u32 s44, s44, 18874368
    v_mov_b32 v8, 0
    v_mov_b32 v9, 0
    v_mov_b32 v10, 0
    v_mov_b32 v11, 0
    v_mov_b32 v12, 0
    v_mov_b32 v13, 0
    v_mov_b32 v14, 0
    v_mov_b32 v15, 0
    v_mov_b32 v16, 0
    v_mov_b32 v17, 0
    v_mov_b32 v18, 0
    v_mov_b32 v19, 0
    v_mov_b32 v20, 0
    v_mov_b32 v21, 0
    v_mov_b32 v22, 0
    v_mov_b32 v23, 0
    v_mov_b32 v97, 0x3f803f80
    s_barrier
    buffer_load_dwordx4 v[88:91], v1, s[12:15], s44 offen sc1
    buffer_load_dwordx4 v[92:95], v1, s[12:15], s44 offen offset:1024 sc1
    ds_read_b128 v[24:27], v98 offset:0
    ds_read_b128 v[28:31], v102 offset:0
    ds_read_b128 v[32:35], v98 offset:1024
    ds_read_b128 v[36:39], v102 offset:2048
    ds_read_b128 v[40:43], v98 offset:2048
    ds_read_b128 v[44:47], v102 offset:4096
    ds_read_b128 v[48:51], v98 offset:3072
    ds_read_b128 v[52:55], v102 offset:6144
    ds_read_b128 v[56:59], v98 offset:4096
    ds_read_b128 v[60:63], v102 offset:8192
    ds_read_b128 v[64:67], v98 offset:5120
    ds_read_b128 v[68:71], v102 offset:10240
    ds_read_b128 v[72:75], v98 offset:6144
    ds_read_b128 v[76:79], v102 offset:12288
    s_waitcnt lgkmcnt(12)
    v_mfma_f32_32x32x16_bf16 v[8:23], v[28:31], v[24:27], v[8:23]
    ds_read_b128 v[80:83], v98 offset:7168
    ds_read_b128 v[84:87], v102 offset:14336
    s_waitcnt lgkmcnt(12)
    v_mfma_f32_32x32x16_bf16 v[8:23], v[36:39], v[32:35], v[8:23]
    s_barrier
    ds_read_b128 v[24:27], v98 offset:16384
    ds_read_b128 v[28:31], v102 offset:16384
    s_waitcnt lgkmcnt(12)
    v_mfma_f32_32x32x16_bf16 v[8:23], v[44:47], v[40:43], v[8:23]
    ds_read_b128 v[32:35], v98 offset:17408
    ds_read_b128 v[36:39], v102 offset:18432
    s_waitcnt lgkmcnt(12)
    v_mfma_f32_32x32x16_bf16 v[8:23], v[52:55], v[48:51], v[8:23]
    ds_read_b128 v[40:43], v98 offset:18432
    ds_read_b128 v[44:47], v102 offset:20480
    s_waitcnt lgkmcnt(12)
    v_mfma_f32_32x32x16_bf16 v[8:23], v[60:63], v[56:59], v[8:23]
    ds_read_b128 v[48:51], v98 offset:19456
    ds_read_b128 v[52:55], v102 offset:22528
    s_waitcnt lgkmcnt(12)
    v_mfma_f32_32x32x16_bf16 v[8:23], v[68:71], v[64:67], v[8:23]
    ds_read_b128 v[56:59], v98 offset:20480
    ds_read_b128 v[60:63], v102 offset:24576
    s_waitcnt lgkmcnt(12)
    v_mfma_f32_32x32x16_bf16 v[8:23], v[76:79], v[72:75], v[8:23]
    ds_read_b128 v[64:67], v98 offset:21504
    ds_read_b128 v[68:71], v102 offset:26624
    s_waitcnt lgkmcnt(12)
    v_mfma_f32_32x32x16_bf16 v[8:23], v[84:87], v[80:83], v[8:23]
    ds_read_b128 v[72:75], v98 offset:22528
    ds_read_b128 v[76:79], v102 offset:28672
    s_waitcnt lgkmcnt(12)
    v_mfma_f32_32x32x16_bf16 v[8:23], v[28:31], v[24:27], v[8:23]
    ds_read_b128 v[80:83], v98 offset:23552
    ds_read_b128 v[84:87], v102 offset:30720
    s_waitcnt lgkmcnt(12)
    v_mfma_f32_32x32x16_bf16 v[8:23], v[36:39], v[32:35], v[8:23]
    s_barrier
    ds_read_b128 v[24:27], v98 offset:32768
    ds_read_b128 v[28:31], v102 offset:32768
    s_waitcnt lgkmcnt(12)
    v_mfma_f32_32x32x16_bf16 v[8:23], v[44:47], v[40:43], v[8:23]
    ds_read_b128 v[32:35], v98 offset:33792
    ds_read_b128 v[36:39], v102 offset:34816
    s_waitcnt lgkmcnt(12)
    v_mfma_f32_32x32x16_bf16 v[8:23], v[52:55], v[48:51], v[8:23]
    ds_read_b128 v[40:43], v98 offset:34816
    ds_read_b128 v[44:47], v102 offset:36864
    s_waitcnt lgkmcnt(12)
    v_mfma_f32_32x32x16_bf16 v[8:23], v[60:63], v[56:59], v[8:23]
    ds_read_b128 v[48:51], v98 offset:35840
    ds_read_b128 v[52:55], v102 offset:38912
    s_waitcnt lgkmcnt(12)
    v_mfma_f32_32x32x16_bf16 v[8:23], v[68:71], v[64:67], v[8:23]
    ds_read_b128 v[56:59], v98 offset:36864
    ds_read_b128 v[60:63], v102 offset:40960
    s_waitcnt lgkmcnt(12)
    v_mfma_f32_32x32x16_bf16 v[8:23], v[76:79], v[72:75], v[8:23]
    ds_read_b128 v[64:67], v98 offset:37888
    ds_read_b128 v[68:71], v102 offset:43008
    s_waitcnt lgkmcnt(12)
    v_mfma_f32_32x32x16_bf16 v[8:23], v[84:87], v[80:83], v[8:23]
    ds_read_b128 v[72:75], v98 offset:38912
    ds_read_b128 v[76:79], v102 offset:45056
    s_waitcnt lgkmcnt(12)
    v_mfma_f32_32x32x16_bf16 v[8:23], v[28:31], v[24:27], v[8:23]
    ds_read_b128 v[80:83], v98 offset:39936
    ds_read_b128 v[84:87], v102 offset:47104
    s_waitcnt lgkmcnt(12)
    v_mfma_f32_32x32x16_bf16 v[8:23], v[36:39], v[32:35], v[8:23]
    s_barrier
    ds_read_b128 v[24:27], v98 offset:49152
    ds_read_b128 v[28:31], v102 offset:49152
    s_waitcnt lgkmcnt(12)
    v_mfma_f32_32x32x16_bf16 v[8:23], v[44:47], v[40:43], v[8:23]
    ds_read_b128 v[32:35], v98 offset:50176
    ds_read_b128 v[36:39], v102 offset:51200
    s_waitcnt lgkmcnt(12)
    v_mfma_f32_32x32x16_bf16 v[8:23], v[52:55], v[48:51], v[8:23]
    ds_read_b128 v[40:43], v98 offset:51200
    ds_read_b128 v[44:47], v102 offset:53248
    s_waitcnt lgkmcnt(12)
    v_mfma_f32_32x32x16_bf16 v[8:23], v[60:63], v[56:59], v[8:23]
    ds_read_b128 v[48:51], v98 offset:52224
    ds_read_b128 v[52:55], v102 offset:55296
    s_waitcnt lgkmcnt(12)
    v_mfma_f32_32x32x16_bf16 v[8:23], v[68:71], v[64:67], v[8:23]
    ds_read_b128 v[56:59], v98 offset:53248
    ds_read_b128 v[60:63], v102 offset:57344
    s_waitcnt lgkmcnt(12)
    v_mfma_f32_32x32x16_bf16 v[8:23], v[76:79], v[72:75], v[8:23]
    ds_read_b128 v[64:67], v98 offset:54272
    ds_read_b128 v[68:71], v102 offset:59392
    s_waitcnt lgkmcnt(12)
    v_mfma_f32_32x32x16_bf16 v[8:23], v[84:87], v[80:83], v[8:23]
    ds_read_b128 v[72:75], v98 offset:55296
    ds_read_b128 v[76:79], v102 offset:61440
    s_waitcnt lgkmcnt(12)
    v_mfma_f32_32x32x16_bf16 v[8:23], v[28:31], v[24:27], v[8:23]
    ds_read_b128 v[80:83], v98 offset:56320
    ds_read_b128 v[84:87], v102 offset:63488
    s_waitcnt lgkmcnt(12)
    v_mfma_f32_32x32x16_bf16 v[8:23], v[36:39], v[32:35], v[8:23]
    s_waitcnt lgkmcnt(10)
    v_mfma_f32_32x32x16_bf16 v[8:23], v[44:47], v[40:43], v[8:23]
    s_waitcnt lgkmcnt(8)
    v_mfma_f32_32x32x16_bf16 v[8:23], v[52:55], v[48:51], v[8:23]
    s_waitcnt lgkmcnt(6)
    v_mfma_f32_32x32x16_bf16 v[8:23], v[60:63], v[56:59], v[8:23]
    s_waitcnt lgkmcnt(4)
    v_mfma_f32_32x32x16_bf16 v[8:23], v[68:71], v[64:67], v[8:23]
    s_waitcnt lgkmcnt(2)
    v_mfma_f32_32x32x16_bf16 v[8:23], v[76:79], v[72:75], v[8:23]
    s_waitcnt lgkmcnt(0)
    v_mfma_f32_32x32x16_bf16 v[8:23], v[84:87], v[80:83], v[8:23]
    s_nop 11
    v_cvt_pk_bf16_f32 v104, v8, v9
    v_cvt_pk_bf16_f32 v105, v10, v11
    v_cvt_pk_bf16_f32 v106, v12, v13
    v_cvt_pk_bf16_f32 v107, v14, v15
    v_cvt_pk_bf16_f32 v108, v16, v17
    v_cvt_pk_bf16_f32 v109, v18, v19
    v_cvt_pk_bf16_f32 v110, v20, v21
    v_cvt_pk_bf16_f32 v111, v22, v23
    v_permlane32_swap_b32 v104, v106
    v_permlane32_swap_b32 v105, v107
    v_permlane32_swap_b32 v108, v110
    v_permlane32_swap_b32 v109, v111
    s_waitcnt vmcnt(0)
    v_lshlrev_b32 v112, 16, v104
    v_and_b32 v113, 0xffff0000, v104
    v_lshlrev_b32 v128, 16, v88
    v_and_b32 v129, 0xffff0000, v88
    v_lshlrev_b32 v114, 16, v105
    v_and_b32 v115, 0xffff0000, v105
    v_lshlrev_b32 v130, 16, v89
    v_and_b32 v131, 0xffff0000, v89
    v_lshlrev_b32 v116, 16, v106
    v_and_b32 v117, 0xffff0000, v106
    v_lshlrev_b32 v132, 16, v90
    v_and_b32 v133, 0xffff0000, v90
    v_lshlrev_b32 v118, 16, v107
    v_and_b32 v119, 0xffff0000, v107
    v_lshlrev_b32 v134, 16, v91
    v_and_b32 v135, 0xffff0000, v91
    v_lshlrev_b32 v120, 16, v108
    v_and_b32 v121, 0xffff0000, v108
    v_lshlrev_b32 v136, 16, v92
    v_and_b32 v137, 0xffff0000, v92
    v_lshlrev_b32 v122, 16, v109
    v_and_b32 v123, 0xffff0000, v109
    v_lshlrev_b32 v138, 16, v93
    v_and_b32 v139, 0xffff0000, v93
    v_lshlrev_b32 v124, 16, v110
    v_and_b32 v125, 0xffff0000, v110
    v_lshlrev_b32 v140, 16, v94
    v_and_b32 v141, 0xffff0000, v94
    v_lshlrev_b32 v126, 16, v111
    v_and_b32 v127, 0xffff0000, v111
    v_lshlrev_b32 v142, 16, v95
    v_and_b32 v143, 0xffff0000, v95
    v_add_f32 v112, v112, v128
    v_add_f32 v113, v113, v129
    v_add_f32 v114, v114, v130
    v_add_f32 v115, v115, v131
    v_add_f32 v116, v116, v132
    v_add_f32 v117, v117, v133
    v_add_f32 v118, v118, v134
    v_add_f32 v119, v119, v135
    v_add_f32 v120, v120, v136
    v_add_f32 v121, v121, v137
    v_add_f32 v122, v122, v138
    v_add_f32 v123, v123, v139
    v_add_f32 v124, v124, v140
    v_add_f32 v125, v125, v141
    v_add_f32 v126, v126, v142
    v_add_f32 v127, v127, v143
    v_cvt_pk_bf16_f32 v104, v112, v113
    v_cvt_pk_bf16_f32 v105, v114, v115
    v_cvt_pk_bf16_f32 v106, v116, v117
    v_cvt_pk_bf16_f32 v107, v118, v119
    v_cvt_pk_bf16_f32 v108, v120, v121
    v_cvt_pk_bf16_f32 v109, v122, v123
    v_cvt_pk_bf16_f32 v110, v124, v125
    v_cvt_pk_bf16_f32 v111, v126, v127
    buffer_store_dwordx4 v[104:107], v1, s[12:15], s45 offen sc1
    buffer_store_dwordx4 v[108:111], v1, s[12:15], s45 offen offset:1024 sc1
    v_mov_b32 v112, 0
    v_mov_b32 v113, 0
    v_dot2_f32_bf16 v112, v104, v97, v112
    v_dot2_f32_bf16 v113, v104, v104, v113
    v_dot2_f32_bf16 v112, v105, v97, v112
    v_dot2_f32_bf16 v113, v105, v105, v113
    v_dot2_f32_bf16 v112, v106, v97, v112
    v_dot2_f32_bf16 v113, v106, v106, v113
    v_dot2_f32_bf16 v112, v107, v97, v112
    v_dot2_f32_bf16 v113, v107, v107, v113
    v_dot2_f32_bf16 v112, v108, v97, v112
    v_dot2_f32_bf16 v113, v108, v108, v113
    v_dot2_f32_bf16 v112, v109, v97, v112
    v_dot2_f32_bf16 v113, v109, v109, v113
    v_dot2_f32_bf16 v112, v110, v97, v112
    v_dot2_f32_bf16 v113, v110, v110, v113
    v_dot2_f32_bf16 v112, v111, v97, v112
    v_dot2_f32_bf16 v113, v111, v111, v113
    s_nop 1
    v_mov_b32 v114, v112
    v_mov_b32 v115, v113
    s_nop 0
    v_permlane32_swap_b32 v114, v112
    v_permlane32_swap_b32 v115, v113
    v_add_f32 v112, v112, v114
    v_add_f32 v113, v113, v115
    v_and_b32 v2, 31, v0
    v_lshlrev_b32 v2, 4, v2
    s_lshl_b32 s46, s37, 12
    s_lshl_b32 s47, s21, 9
    s_add_u32 s46, s46, s47
    s_lshl_b32 s47, s36, 3
    s_add_u32 s46, s46, s47
    s_add_u32 s46, s46, s16
    s_add_u32 s46, s46, 22020096
    buffer_store_dwordx2 v[112:113], v2, s[12:15], s46 offen sc1
    s_lshr_b32 s40, s20, 1
    s_lshl_b32 s40, s40, 4
    v_add_u32 v2, s40, v0
    s_movk_i32 s41, 0x100
    v_cmp_gt_u32 s[42:43], s41, v2
    v_lshlrev_b32 v2, 7, v2
    v_mov_b32 v3, 1
    s_add_u32 s40, s17, 65536
    s_and_b32 s42, s42, 0xffff
    s_mov_b32 s43, 0
    s_waitcnt vmcnt(0)
    s_barrier
    s_cmp_lg_u32 s19, 0
    s_cbranch_scc1 mega_kernel_sg54
    s_mov_b64 exec, s[42:43]
    buffer_atomic_add v3, v2, s[12:15], s40 offen sc1
    s_mov_b64 exec, -1
mega_kernel_sg54:
    s_branch mega_kernel_p3end51
mega_kernel_p3idle50:
    s_barrier
    s_barrier
    s_barrier
    s_barrier
    s_barrier
mega_kernel_p3end51:
    s_and_b32 s35, s19, 3
    s_lshr_b32 s36, s19, 2
    s_lshl_b32 s37, s28, 2
    s_add_u32 s37, s37, s35
    s_lshl_b32 s41, s35, 12
    v_add_u32 v125, s41, v1
    s_lshl_b32 s41, s36, 11
    s_add_u32 s41, s41, 65536
    v_add_u32 v126, s41, v1
    v_mov_b32 v8, 0
    v_mov_b32 v9, 0
    v_mov_b32 v10, 0
    v_mov_b32 v11, 0
    v_mov_b32 v12, 0
    v_mov_b32 v13, 0
    v_mov_b32 v14, 0
    v_mov_b32 v15, 0
    v_mov_b32 v16, 0
    v_mov_b32 v17, 0
    v_mov_b32 v18, 0
    v_mov_b32 v19, 0
    v_mov_b32 v20, 0
    v_mov_b32 v21, 0
    v_mov_b32 v22, 0
    v_mov_b32 v23, 0
    v_mov_b32 v24, 0
    v_mov_b32 v25, 0
    v_mov_b32 v26, 0
    v_mov_b32 v27, 0
    v_mov_b32 v28, 0
    v_mov_b32 v29, 0
    v_mov_b32 v30, 0
    v_mov_b32 v31, 0
    v_mov_b32 v32, 0
    v_mov_b32 v33, 0
    v_mov_b32 v34, 0
    v_mov_b32 v35, 0
    v_mov_b32 v36, 0
    v_mov_b32 v37, 0
    v_mov_b32 v38, 0
    v_mov_b32 v39, 0
    v_mov_b32 v40, 0
    v_mov_b32 v41, 0
    v_mov_b32 v42, 0
    v_mov_b32 v43, 0
    v_mov_b32 v44, 0
    v_mov_b32 v45, 0
    v_mov_b32 v46, 0
    v_mov_b32 v47, 0
    v_mov_b32 v48, 0
    v_mov_b32 v49, 0
    v_mov_b32 v50, 0
    v_mov_b32 v51, 0
    v_mov_b32 v52, 0
    v_mov_b32 v53, 0
    v_mov_b32 v54, 0
    v_mov_b32 v55, 0
    v_mov_b32 v56, 0
    v_mov_b32 v57, 0
    v_mov_b32 v58, 0
    v_mov_b32 v59, 0
    v_mov_b32 v60, 0
    v_mov_b32 v61, 0
    v_mov_b32 v62, 0
    v_mov_b32 v63, 0
    v_mov_b32 v64, 0
    v_mov_b32 v65, 0
    v_mov_b32 v66, 0
    v_mov_b32 v67, 0
    v_mov_b32 v68, 0
    v_mov_b32 v69, 0
    v_mov_b32 v70, 0
    v_mov_b32 v71, 0
    v_mov_b32 v2, 151552
    ds_write_b32 v2, v8
    v_lshrrev_b32 v3, 5, v0
    v_and_b32 v2, 31, v0
    v_lshlrev_b32 v2, 4, v2
    v_lshl_add_u32 v2, v3, 11, v2
    s_lshl_b32 s46, s35, 12
    s_add_u32 s46, s46, 131072
    v_add_u32 v2, s46, v2
    v_and_b32 v4, 31, v0
    v_lshlrev_b32 v4, 4, v4
    s_lshl_b32 s47, s36, 10
    s_add_u32 s47, s47, 147456
    v_add_u32 v128, s47, v4
    s_mul_i32 s44, s37, 114688
    s_add_u32 s44, s44, 10485760
    s_add_u32 s44, s44, s16
    s_lshl_b32 s46, s36, 11
    s_add_u32 s44, s44, s46
    s_mul_i32 s45, s29, 3072
    s_add_u32 s45, s45, s44
    s_add_u32 s45, s45, 65536
    s_lshl_b32 s46, s29, 12
    s_add_u32 s44, s44, s46
    s_cmp_lg_u32 s36, 0
    s_cbranch_scc1 mega_kernel_p4b65
    s_barrier
    ds_read_b128 v[72:75], v125 offset:0
    ds_read_b128 v[76:79], v126 offset:0
    ds_read_b128 v[80:83], v126 offset:1024
    ds_read_b128 v[84:87], v125 offset:1024
    ds_read_b128 v[88:91], v126 offset:4096
    ds_read_b128 v[92:95], v126 offset:5120
    s_waitcnt lgkmcnt(3)
    v_mfma_f32_32x32x16_bf16 v[8:23], v[76:79], v[72:75], v[8:23]
    ds_read_b128 v[96:99], v125 offset:2048
    ds_read_b128 v[100:103], v126 offset:8192
    v_mfma_f32_32x32x16_bf16 v[24:39], v[80:83], v[72:75], v[24:39]
    ds_read_b128 v[104:107], v126 offset:9216
    s_waitcnt lgkmcnt(3)
    v_mfma_f32_32x32x16_bf16 v[8:23], v[88:91], v[84:87], v[8:23]
    ds_read_b128 v[108:111], v125 offset:3072
    ds_read_b128 v[112:115], v126 offset:12288
    v_mfma_f32_32x32x16_bf16 v[24:39], v[92:95], v[84:87], v[24:39]
    ds_read_b128 v[116:119], v126 offset:13312
    s_waitcnt lgkmcnt(3)
    s_barrier
    v_mfma_f32_32x32x16_bf16 v[8:23], v[100:103], v[96:99], v[8:23]
    ds_read_b128 v[72:75], v125 offset:16384
    ds_read_b128 v[76:79], v126 offset:16384
    v_mfma_f32_32x32x16_bf16 v[24:39], v[104:107], v[96:99], v[24:39]
    ds_read_b128 v[80:83], v126 offset:17408
    s_waitcnt lgkmcnt(3)
    v_mfma_f32_32x32x16_bf16 v[8:23], v[112:115], v[108:111], v[8:23]
    ds_read_b128 v[84:87], v125 offset:17408
    ds_read_b128 v[88:91], v126 offset:20480
    v_mfma_f32_32x32x16_bf16 v[24:39], v[116:119], v[108:111], v[24:39]
    ds_read_b128 v[92:95], v126 offset:21504
    s_waitcnt lgkmcnt(3)
    v_mfma_f32_32x32x16_bf16 v[8:23], v[76:79], v[72:75], v[8:23]
    ds_read_b128 v[96:99], v125 offset:18432
    ds_read_b128 v[100:103], v126 offset:24576
    v_mfma_f32_32x32x16_bf16 v[24:39], v[80:83], v[72:75], v[24:39]
    ds_read_b128 v[104:107], v126 offset:25600
    s_waitcnt lgkmcnt(3)
    v_mfma_f32_32x32x16_bf16 v[8:23], v[88:91], v[84:87], v[8:23]
    ds_read_b128 v[108:111], v125 offset:19456
    ds_read_b128 v[112:115], v126 offset:28672
    v_mfma_f32_32x32x16_bf16 v[24:39], v[92:95], v[84:87], v[24:39]
    ds_read_b128 v[116:119], v126 offset:29696
    s_waitcnt lgkmcnt(3)
    s_barrier
    v_mfma_f32_32x32x16_bf16 v[8:23], v[100:103], v[96:99], v[8:23]
    ds_read_b128 v[72:75], v125 offset:32768
    ds_read_b128 v[76:79], v126 offset:32768
    v_mfma_f32_32x32x16_bf16 v[24:39], v[104:107], v[96:99], v[24:39]
    ds_read_b128 v[80:83], v126 offset:33792
    s_waitcnt lgkmcnt(3)
    v_mfma_f32_32x32x16_bf16 v[8:23], v[112:115], v[108:111], v[8:23]
    ds_read_b128 v[84:87], v125 offset:33792
    ds_read_b128 v[88:91], v126 offset:36864
    v_mfma_f32_32x32x16_bf16 v[24:39], v[116:119], v[108:111], v[24:39]
    ds_read_b128 v[92:95], v126 offset:37888
    s_waitcnt lgkmcnt(3)
    v_mfma_f32_32x32x16_bf16 v[8:23], v[76:79], v[72:75], v[8:23]
    ds_read_b128 v[96:99], v125 offset:34816
    ds_read_b128 v[100:103], v126 offset:40960
    v_mfma_f32_32x32x16_bf16 v[24:39], v[80:83], v[72:75], v[24:39]
    ds_read_b128 v[104:107], v126 offset:41984
    s_waitcnt lgkmcnt(3)
    v_mfma_f32_32x32x16_bf16 v[8:23], v[88:91], v[84:87], v[8:23]
    ds_read_b128 v[108:111], v125 offset:35840
    ds_read_b128 v[112:115], v126 offset:45056
    v_mfma_f32_32x32x16_bf16 v[24:39], v[92:95], v[84:87], v[24:39]
    ds_read_b128 v[116:119], v126 offset:46080
    s_waitcnt lgkmcnt(3)
    s_barrier
    v_mfma_f32_32x32x16_bf16 v[8:23], v[100:103], v[96:99], v[8:23]
    ds_read_b128 v[72:75], v125 offset:49152
    ds_read_b128 v[76:79], v126 offset:49152
    v_mfma_f32_32x32x16_bf16 v[24:39], v[104:107], v[96:99], v[24:39]
    ds_read_b128 v[80:83], v126 offset:50176
    s_waitcnt lgkmcnt(3)
    v_mfma_f32_32x32x16_bf16 v[8:23], v[112:115], v[108:111], v[8:23]
    ds_read_b128 v[84:87], v125 offset:50176
    ds_read_b128 v[88:91], v126 offset:53248
    v_mfma_f32_32x32x16_bf16 v[24:39], v[116:119], v[108:111], v[24:39]
    ds_read_b128 v[92:95], v126 offset:54272
    s_waitcnt lgkmcnt(3)
    v_mfma_f32_32x32x16_bf16 v[8:23], v[76:79], v[72:75], v[8:23]
    ds_read_b128 v[96:99], v125 offset:51200
    ds_read_b128 v[100:103], v126 offset:57344
    v_mfma_f32_32x32x16_bf16 v[24:39], v[80:83], v[72:75], v[24:39]
    ds_read_b128 v[104:107], v126 offset:58368
    ds_read_b128 v[142:145], v2 offset:0
    ds_read_b128 v[146:149], v2 offset:512
    ds_read_b128 v[150:153], v2 offset:1024
    ds_read_b128 v[154:157], v2 offset:1536
    s_waitcnt lgkmcnt(0)
    v_mfma_f32_32x32x16_bf16 v[8:23], v[88:91], v[84:87], v[8:23]
    ds_read_b128 v[108:111], v125 offset:52224
    ds_read_b128 v[112:115], v126 offset:61440
    v_mfma_f32_32x32x16_bf16 v[24:39], v[92:95], v[84:87], v[24:39]
    ds_read_b128 v[116:119], v126 offset:62464
    v_add_f32 v134, v142, v144
    v_add_f32 v135, v143, v145
    v_add_f32 v134, v134, v146
    v_add_f32 v135, v135, v147
    v_add_f32 v134, v134, v148
    v_add_f32 v135, v135, v149
    v_add_f32 v134, v134, v150
    v_add_f32 v135, v135, v151
    v_add_f32 v134, v134, v152
    v_add_f32 v135, v135, v153
    v_add_f32 v134, v134, v154
    v_add_f32 v135, v135, v155
    v_add_f32 v134, v134, v156
    v_add_f32 v135, v135, v157
    v_mov_b32 v136, v134
    v_mov_b32 v137, v135
    s_nop 0
    v_permlane32_swap_b32 v136, v134
    v_permlane32_swap_b32 v137, v135
    v_add_f32 v134, v134, v136
    v_add_f32 v135, v135, v137
    v_mul_f32 v134, 0x3b000000, v134
    v_mul_f32 v135, 0x3b000000, v135
    v_fma_f32 v135, -v134, v134, v135
    v_max_f32 v135, 0, v135
    v_cvt_pk_bf16_f32 v120, v134, v134
    v_lshlrev_b32 v120, 16, v120
    v_cvt_pk_bf16_f32 v136, v135, v135
    v_lshlrev_b32 v136, 16, v136
    v_add_f32 v136, 0x3727c5ac, v136
    v_cvt_pk_bf16_f32 v136, v136, v136
    v_lshlrev_b32 v136, 16, v136
    v_sqrt_f32 v136, v136
    s_nop 0
    v_cvt_pk_bf16_f32 v136, v136, v136
    v_lshlrev_b32 v136, 16, v136
    v_rcp_f32 v121, v136
    v_mul_f32 v122, v136, v136
    v_mul_f32 v123, 0xc0135761, v121
    v_mul_f32 v124, v121, v121
    v_mul_f32 v124, v124, v123
    v_mul_f32 v124, 0x3d372713, v124
    v_mov_b32 v130, 0
    v_mov_b32 v131, 0
    v_mov_b32 v132, 0
    v_mov_b32 v133, 0
    s_mov_b32 exec_hi, 0
    v_xor_b32 v130, 0x80000000, v120
    v_lshrrev_b32 v131, 16, v130
    v_or_b32 v130, v130, v131
    s_mov_b32 exec_hi, -1
    s_waitcnt lgkmcnt(3)
    s_barrier
    v_mfma_f32_32x32x16_bf16 v[8:23], v[100:103], v[96:99], v[8:23]
    ds_read_b128 v[72:75], v125 offset:0
    ds_read_b128 v[76:79], v126 offset:0
    v_mfma_f32_32x32x16_bf16 v[24:39], v[104:107], v[96:99], v[24:39]
    ds_read_b128 v[80:83], v126 offset:1024
    s_waitcnt lgkmcnt(3)
    v_mfma_f32_32x32x16_bf16 v[8:23], v[112:115], v[108:111], v[8:23]
    ds_read_b128 v[84:87], v125 offset:1024
    ds_read_b128 v[88:91], v126 offset:4096
    v_mfma_f32_32x32x16_bf16 v[24:39], v[116:119], v[108:111], v[24:39]
    ds_read_b128 v[92:95], v126 offset:5120
    s_waitcnt lgkmcnt(3)
    v_mfma_f32_32x32x16_bf16 v[8:23], v[76:79], v[72:75], v[8:23]
    ds_read_b128 v[96:99], v125 offset:2048
    ds_read_b128 v[100:103], v126 offset:8192
    v_mfma_f32_32x32x16_bf16 v[24:39], v[80:83], v[72:75], v[24:39]
    ds_read_b128 v[104:107], v126 offset:9216
    ds_read_b128 v[142:145], v128 offset:0
    ds_read_b128 v[146:149], v128 offset:512
    s_waitcnt lgkmcnt(3)
    v_mfma_f32_32x32x16_bf16 v[8:23], v[88:91], v[84:87], v[8:23]
    ds_read_b128 v[108:111], v125 offset:3072
    ds_read_b128 v[112:115], v126 offset:12288
    v_mfma_f32_32x32x16_bf16 v[24:39], v[92:95], v[84:87], v[24:39]
    ds_read_b128 v[116:119], v126 offset:13312
    s_waitcnt lgkmcnt(0)
    s_barrier
    v_mfma_f32_32x32x16_bf16 v[8:23], v[100:103], v[96:99], v[8:23]
    ds_read_b128 v[72:75], v125 offset:16384
    ds_read_b128 v[76:79], v126 offset:16384
    v_mfma_f32_32x32x16_bf16 v[24:39], v[104:107], v[96:99], v[24:39]
    ds_read_b128 v[80:83], v126 offset:17408
    v_mfma_f32_32x32x16_bf16 v[8:23], v[142:145], v[130:133], v[8:23]
    v_mfma_f32_32x32x16_bf16 v[24:39], v[146:149], v[130:133], v[24:39]
    s_waitcnt lgkmcnt(3)
    v_mfma_f32_32x32x16_bf16 v[8:23], v[112:115], v[108:111], v[8:23]
    ds_read_b128 v[84:87], v125 offset:17408
    ds_read_b128 v[88:91], v126 offset:20480
    v_mfma_f32_32x32x16_bf16 v[24:39], v[116:119], v[108:111], v[24:39]
    ds_read_b128 v[92:95], v126 offset:21504
    s_waitcnt lgkmcnt(3)
    v_mfma_f32_32x32x16_bf16 v[8:23], v[76:79], v[72:75], v[8:23]
    ds_read_b128 v[96:99], v125 offset:18432
    ds_read_b128 v[100:103], v126 offset:24576
    v_mfma_f32_32x32x16_bf16 v[24:39], v[80:83], v[72:75], v[24:39]
    ds_read_b128 v[104:107], v126 offset:25600
    s_waitcnt lgkmcnt(3)
    v_mfma_f32_32x32x16_bf16 v[8:23], v[88:91], v[84:87], v[8:23]
    ds_read_b128 v[108:111], v125 offset:19456
    ds_read_b128 v[112:115], v126 offset:28672
    v_mfma_f32_32x32x16_bf16 v[24:39], v[92:95], v[84:87], v[24:39]
    ds_read_b128 v[116:119], v126 offset:29696
    s_waitcnt lgkmcnt(0)
    s_barrier
    v_mfma_f32_32x32x16_bf16 v[8:23], v[100:103], v[96:99], v[8:23]
    ds_read_b128 v[72:75], v125 offset:32768
    ds_read_b128 v[76:79], v126 offset:32768
    v_mfma_f32_32x32x16_bf16 v[24:39], v[104:107], v[96:99], v[24:39]
    ds_read_b128 v[80:83], v126 offset:33792
    s_waitcnt lgkmcnt(3)
    v_mfma_f32_32x32x16_bf16 v[8:23], v[112:115], v[108:111], v[8:23]
    ds_read_b128 v[84:87], v125 offset:33792
    ds_read_b128 v[88:91], v126 offset:36864
    v_mfma_f32_32x32x16_bf16 v[24:39], v[116:119], v[108:111], v[24:39]
    ds_read_b128 v[92:95], v126 offset:37888
    s_waitcnt lgkmcnt(3)
    v_mfma_f32_32x32x16_bf16 v[8:23], v[76:79], v[72:75], v[8:23]
    ds_read_b128 v[96:99], v125 offset:34816
    ds_read_b128 v[100:103], v126 offset:40960
    v_mfma_f32_32x32x16_bf16 v[24:39], v[80:83], v[72:75], v[24:39]
    ds_read_b128 v[104:107], v126 offset:41984
    s_waitcnt lgkmcnt(3)
    v_mfma_f32_32x32x16_bf16 v[8:23], v[88:91], v[84:87], v[8:23]
    ds_read_b128 v[108:111], v125 offset:35840
    ds_read_b128 v[112:115], v126 offset:45056
    v_mfma_f32_32x32x16_bf16 v[24:39], v[92:95], v[84:87], v[24:39]
    ds_read_b128 v[116:119], v126 offset:46080
    s_waitcnt lgkmcnt(0)
    s_barrier
    v_mfma_f32_32x32x16_bf16 v[8:23], v[100:103], v[96:99], v[8:23]
    ds_read_b128 v[72:75], v125 offset:49152
    ds_read_b128 v[76:79], v126 offset:49152
    v_mfma_f32_32x32x16_bf16 v[24:39], v[104:107], v[96:99], v[24:39]
    ds_read_b128 v[80:83], v126 offset:50176
    s_waitcnt lgkmcnt(3)
    v_mfma_f32_32x32x16_bf16 v[8:23], v[112:115], v[108:111], v[8:23]
    ds_read_b128 v[84:87], v125 offset:50176
    ds_read_b128 v[88:91], v126 offset:53248
    v_mfma_f32_32x32x16_bf16 v[24:39], v[116:119], v[108:111], v[24:39]
    ds_read_b128 v[92:95], v126 offset:54272
    s_waitcnt lgkmcnt(3)
    v_mfma_f32_32x32x16_bf16 v[8:23], v[76:79], v[72:75], v[8:23]
    ds_read_b128 v[96:99], v125 offset:51200
    ds_read_b128 v[100:103], v126 offset:57344
    v_mfma_f32_32x32x16_bf16 v[24:39], v[80:83], v[72:75], v[24:39]
    ds_read_b128 v[104:107], v126 offset:58368
    s_waitcnt lgkmcnt(3)
    v_mfma_f32_32x32x16_bf16 v[8:23], v[88:91], v[84:87], v[8:23]
    ds_read_b128 v[108:111], v125 offset:52224
    ds_read_b128 v[112:115], v126 offset:61440
    v_mfma_f32_32x32x16_bf16 v[24:39], v[92:95], v[84:87], v[24:39]
    ds_read_b128 v[116:119], v126 offset:62464
    s_waitcnt lgkmcnt(0)
    s_barrier
    v_mfma_f32_32x32x16_bf16 v[8:23], v[100:103], v[96:99], v[8:23]
    ds_read_b128 v[72:75], v125 offset:0
    ds_read_b128 v[76:79], v126 offset:0
    v_mfma_f32_32x32x16_bf16 v[24:39], v[104:107], v[96:99], v[24:39]
    ds_read_b128 v[80:83], v126 offset:1024
    s_waitcnt lgkmcnt(3)
    v_mfma_f32_32x32x16_bf16 v[8:23], v[112:115], v[108:111], v[8:23]
    ds_read_b128 v[84:87], v125 offset:1024
    ds_read_b128 v[88:91], v126 offset:3072
    v_mfma_f32_32x32x16_bf16 v[24:39], v[116:119], v[108:111], v[24:39]
    ds_read_b128 v[92:95], v126 offset:4096
    s_waitcnt lgkmcnt(3)
    v_mfma_f32_32x32x16_bf16 v[40:55], v[76:79], v[72:75], v[40:55]
    ds_read_b128 v[96:99], v125 offset:2048
    ds_read_b128 v[100:103], v126 offset:6144
    v_mfma_f32_32x32x16_bf16 v[56:71], v[80:83], v[72:75], v[56:71]
    ds_read_b128 v[104:107], v126 offset:7168
    s_waitcnt lgkmcnt(3)
    v_mfma_f32_32x32x16_bf16 v[40:55], v[88:91], v[84:87], v[40:55]
    ds_read_b128 v[108:111], v125 offset:3072
    ds_read_b128 v[112:115], v126 offset:9216
    v_mul_f32 v134, v8, v8
    v_mul_f32 v135, v9, v9
    v_mul_f32 v136, v10, v10
    v_mul_f32 v137, v11, v11
    v_mul_f32 v138, v12, v12
    v_mul_f32 v139, v13, v13
    v_mul_f32 v140, v14, v14
    v_mfma_f32_32x32x16_bf16 v[56:71], v[92:95], v[84:87], v[56:71]
    ds_read_b128 v[116:119], v126 offset:10240
    v_mul_f32 v141, v15, v15
    v_fma_f32 v134, v134, v124, v123
    v_fma_f32 v135, v135, v124, v123
    v_fma_f32 v136, v136, v124, v123
    v_fma_f32 v137, v137, v124, v123
    v_fma_f32 v138, v138, v124, v123
    v_fma_f32 v139, v139, v124, v123
    s_waitcnt lgkmcnt(0)
    s_barrier
    v_mfma_f32_32x32x16_bf16 v[40:55], v[100:103], v[96:99], v[40:55]
    ds_read_b128 v[72:75], v125 offset:16384
    ds_read_b128 v[76:79], v126 offset:16384
    v_fma_f32 v140, v140, v124, v123
    v_fma_f32 v141, v141, v124, v123
    v_mul_f32 v134, v134, v8
    v_mul_f32 v135, v135, v9
    v_mul_f32 v136, v136, v10
    v_mul_f32 v137, v137, v11
    v_mul_f32 v138, v138, v12
    v_mfma_f32_32x32x16_bf16 v[56:71], v[104:107], v[96:99], v[56:71]
    ds_read_b128 v[80:83], v126 offset:17408
    v_mul_f32 v139, v139, v13
    v_mul_f32 v140, v140, v14
    v_mul_f32 v141, v141, v15
    v_exp_f32 v134, v134
    v_exp_f32 v135, v135
    v_exp_f32 v136, v136
    v_exp_f32 v137, v137
    s_waitcnt lgkmcnt(3)
    v_mfma_f32_32x32x16_bf16 v[40:55], v[112:115], v[108:111], v[40:55]
    ds_read_b128 v[84:87], v125 offset:17408
    ds_read_b128 v[88:91], v126 offset:19456
    v_exp_f32 v138, v138
    v_exp_f32 v139, v139
    v_exp_f32 v140, v140
    v_exp_f32 v141, v141
    v_mul_f32 v8, v8, v16
    v_mul_f32 v9, v9, v17
    v_mul_f32 v10, v10, v18
    v_mfma_f32_32x32x16_bf16 v[56:71], v[116:119], v[108:111], v[56:71]
    ds_read_b128 v[92:95], v126 offset:20480
    v_mul_f32 v11, v11, v19
    v_mul_f32 v12, v12, v20
    v_mul_f32 v13, v13, v21
    v_mul_f32 v14, v14, v22
    v_mul_f32 v15, v15, v23
    v_fma_f32 v134, v134, v122, v122
    v_fma_f32 v135, v135, v122, v122
    s_waitcnt lgkmcnt(3)
    v_mfma_f32_32x32x16_bf16 v[40:55], v[76:79], v[72:75], v[40:55]
    ds_read_b128 v[96:99], v125 offset:18432
    ds_read_b128 v[100:103], v126 offset:22528
    v_fma_f32 v136, v136, v122, v122
    v_fma_f32 v137, v137, v122, v122
    v_fma_f32 v138, v138, v122, v122
    v_fma_f32 v139, v139, v122, v122
    v_fma_f32 v140, v140, v122, v122
    v_fma_f32 v141, v141, v122, v122
    v_rcp_f32 v134, v134
    v_mfma_f32_32x32x16_bf16 v[56:71], v[80:83], v[72:75], v[56:71]
    ds_read_b128 v[104:107], v126 offset:23552
    v_rcp_f32 v135, v135
    v_rcp_f32 v136, v136
    v_rcp_f32 v137, v137
    v_rcp_f32 v138, v138
    v_rcp_f32 v139, v139
    v_rcp_f32 v140, v140
    v_rcp_f32 v141, v141
    ds_read_b128 v[142:145], v128 offset:2048
    ds_read_b128 v[146:149], v128 offset:2560
    s_waitcnt lgkmcnt(3)
    v_mfma_f32_32x32x16_bf16 v[40:55], v[88:91], v[84:87], v[40:55]
    ds_read_b128 v[108:111], v125 offset:19456
    ds_read_b128 v[112:115], v126 offset:25600
    v_mul_f32 v8, v8, v134
    v_mul_f32 v9, v9, v135
    v_mul_f32 v10, v10, v136
    v_mul_f32 v11, v11, v137
    v_mul_f32 v12, v12, v138
    v_mul_f32 v13, v13, v139
    v_mul_f32 v14, v14, v140
    v_mfma_f32_32x32x16_bf16 v[56:71], v[92:95], v[84:87], v[56:71]
    ds_read_b128 v[116:119], v126 offset:26624
    v_mul_f32 v15, v15, v141
    v_cvt_pk_bf16_f32 v158, v8, v9
    v_cvt_pk_bf16_f32 v159, v10, v11
    v_cvt_pk_bf16_f32 v160, v12, v13
    v_cvt_pk_bf16_f32 v161, v14, v15
    buffer_store_dwordx4 v[158:161], v1, s[12:15], s44 offen offset:0 sc1
    v_mul_f32 v134, v24, v24
    s_waitcnt lgkmcnt(0)
    s_barrier
    v_mfma_f32_32x32x16_bf16 v[40:55], v[100:103], v[96:99], v[40:55]
    ds_read_b128 v[72:75], v125 offset:32768
    ds_read_b128 v[76:79], v126 offset:32768
    v_mul_f32 v135, v25, v25
    v_mul_f32 v136, v26, v26
    v_mul_f32 v137, v27, v27
    v_mul_f32 v138, v28, v28
    v_mul_f32 v139, v29, v29
    v_mul_f32 v140, v30, v30
    v_mul_f32 v141, v31, v31
    v_mfma_f32_32x32x16_bf16 v[56:71], v[104:107], v[96:99], v[56:71]
    ds_read_b128 v[80:83], v126 offset:33792
    v_fma_f32 v134, v134, v124, v123
    v_fma_f32 v135, v135, v124, v123
    v_fma_f32 v136, v136, v124, v123
    v_fma_f32 v137, v137, v124, v123
    v_fma_f32 v138, v138, v124, v123
    v_fma_f32 v139, v139, v124, v123
    v_fma_f32 v140, v140, v124, v123
    v_mfma_f32_32x32x16_bf16 v[40:55], v[142:145], v[130:133], v[40:55]
    v_mfma_f32_32x32x16_bf16 v[56:71], v[146:149], v[130:133], v[56:71]
    s_waitcnt lgkmcnt(3)
    v_mfma_f32_32x32x16_bf16 v[40:55], v[112:115], v[108:111], v[40:55]
    ds_read_b128 v[84:87], v125 offset:33792
    ds_read_b128 v[88:91], v126 offset:35840
    v_fma_f32 v141, v141, v124, v123
    v_mul_f32 v134, v134, v24
    v_mul_f32 v135, v135, v25
    v_mul_f32 v136, v136, v26
    v_mul_f32 v137, v137, v27
    v_mul_f32 v138, v138, v28
    v_mul_f32 v139, v139, v29
    v_mfma_f32_32x32x16_bf16 v[56:71], v[116:119], v[108:111], v[56:71]
    ds_read_b128 v[92:95], v126 offset:36864
    v_mul_f32 v140, v140, v30
    v_mul_f32 v141, v141, v31
    v_exp_f32 v134, v134
    v_exp_f32 v135, v135
    v_exp_f32 v136, v136
    v_exp_f32 v137, v137
    v_exp_f32 v138, v138
    s_waitcnt lgkmcnt(3)
    v_mfma_f32_32x32x16_bf16 v[40:55], v[76:79], v[72:75], v[40:55]
    ds_read_b128 v[96:99], v125 offset:34816
    ds_read_b128 v[100:103], v126 offset:38912
    v_exp_f32 v139, v139
    v_exp_f32 v140, v140
    v_exp_f32 v141, v141
    v_mul_f32 v24, v24, v32
    v_mul_f32 v25, v25, v33
    v_mul_f32 v26, v26, v34
    v_mul_f32 v27, v27, v35
    v_mfma_f32_32x32x16_bf16 v[56:71], v[80:83], v[72:75], v[56:71]
    ds_read_b128 v[104:107], v126 offset:39936
    v_mul_f32 v28, v28, v36
    v_mul_f32 v29, v29, v37
    v_mul_f32 v30, v30, v38
    v_mul_f32 v31, v31, v39
    v_fma_f32 v134, v134, v122, v122
    v_fma_f32 v135, v135, v122, v122
    v_fma_f32 v136, v136, v122, v122
    s_waitcnt lgkmcnt(3)
    v_mfma_f32_32x32x16_bf16 v[40:55], v[88:91], v[84:87], v[40:55]
    ds_read_b128 v[108:111], v125 offset:35840
    ds_read_b128 v[112:115], v126 offset:41984
    v_fma_f32 v137, v137, v122, v122
    v_fma_f32 v138, v138, v122, v122
    v_fma_f32 v139, v139, v122, v122
    v_fma_f32 v140, v140, v122, v122
    v_fma_f32 v141, v141, v122, v122
    v_rcp_f32 v134, v134
    v_rcp_f32 v135, v135
    v_mfma_f32_32x32x16_bf16 v[56:71], v[92:95], v[84:87], v[56:71]
    ds_read_b128 v[116:119], v126 offset:43008
    v_rcp_f32 v136, v136
    v_rcp_f32 v137, v137
    v_rcp_f32 v138, v138
    v_rcp_f32 v139, v139
    v_rcp_f32 v140, v140
    v_rcp_f32 v141, v141
    v_mul_f32 v24, v24, v134
    s_waitcnt lgkmcnt(0)
    s_barrier
    v_mfma_f32_32x32x16_bf16 v[40:55], v[100:103], v[96:99], v[40:55]
    ds_read_b128 v[72:75], v125 offset:49152
    ds_read_b128 v[76:79], v126 offset:49152
    v_mul_f32 v25, v25, v135
    v_mul_f32 v26, v26, v136
    v_mul_f32 v27, v27, v137
    v_mul_f32 v28, v28, v138
    v_mul_f32 v29, v29, v139
    v_mul_f32 v30, v30, v140
    v_mul_f32 v31, v31, v141
    v_mfma_f32_32x32x16_bf16 v[56:71], v[104:107], v[96:99], v[56:71]
    ds_read_b128 v[80:83], v126 offset:50176
    v_cvt_pk_bf16_f32 v162, v24, v25
    v_cvt_pk_bf16_f32 v163, v26, v27
    v_cvt_pk_bf16_f32 v164, v28, v29
    v_cvt_pk_bf16_f32 v165, v30, v31
    buffer_store_dwordx4 v[162:165], v1, s[12:15], s44 offen offset:1024 sc1
    s_waitcnt lgkmcnt(3)
    v_mfma_f32_32x32x16_bf16 v[40:55], v[112:115], v[108:111], v[40:55]
    ds_read_b128 v[84:87], v125 offset:50176
    ds_read_b128 v[88:91], v126 offset:52224
    v_mfma_f32_32x32x16_bf16 v[56:71], v[116:119], v[108:111], v[56:71]
    ds_read_b128 v[92:95], v126 offset:53248
    s_waitcnt lgkmcnt(3)
    v_mfma_f32_32x32x16_bf16 v[40:55], v[76:79], v[72:75], v[40:55]
    ds_read_b128 v[96:99], v125 offset:51200
    ds_read_b128 v[100:103], v126 offset:55296
    v_mfma_f32_32x32x16_bf16 v[56:71], v[80:83], v[72:75], v[56:71]
    ds_read_b128 v[104:107], v126 offset:56320
    s_waitcnt lgkmcnt(3)
    v_mfma_f32_32x32x16_bf16 v[40:55], v[88:91], v[84:87], v[40:55]
    ds_read_b128 v[108:111], v125 offset:52224
    ds_read_b128 v[112:115], v126 offset:58368
    v_mfma_f32_32x32x16_bf16 v[56:71], v[92:95], v[84:87], v[56:71]
    ds_read_b128 v[116:119], v126 offset:59392
    s_waitcnt lgkmcnt(0)
    s_barrier
    v_mfma_f32_32x32x16_bf16 v[40:55], v[100:103], v[96:99], v[40:55]
    ds_read_b128 v[72:75], v125 offset:0
    ds_read_b128 v[76:79], v126 offset:0
    v_mfma_f32_32x32x16_bf16 v[56:71], v[104:107], v[96:99], v[56:71]
    ds_read_b128 v[80:83], v126 offset:1024
    s_waitcnt lgkmcnt(3)
    v_mfma_f32_32x32x16_bf16 v[40:55], v[112:115], v[108:111], v[40:55]
    ds_read_b128 v[84:87], v125 offset:1024
    ds_read_b128 v[88:91], v126 offset:3072
    v_mfma_f32_32x32x16_bf16 v[56:71], v[116:119], v[108:111], v[56:71]
    ds_read_b128 v[92:95], v126 offset:4096
    s_waitcnt lgkmcnt(3)
    v_mfma_f32_32x32x16_bf16 v[40:55], v[76:79], v[72:75], v[40:55]
    ds_read_b128 v[96:99], v125 offset:2048
    ds_read_b128 v[100:103], v126 offset:6144
    v_mfma_f32_32x32x16_bf16 v[56:71], v[80:83], v[72:75], v[56:71]
    ds_read_b128 v[104:107], v126 offset:7168
    s_waitcnt lgkmcnt(3)
    v_mfma_f32_32x32x16_bf16 v[40:55], v[88:91], v[84:87], v[40:55]
    ds_read_b128 v[108:111], v125 offset:3072
    ds_read_b128 v[112:115], v126 offset:9216
    v_mfma_f32_32x32x16_bf16 v[56:71], v[92:95], v[84:87], v[56:71]
    ds_read_b128 v[116:119], v126 offset:10240
    s_waitcnt lgkmcnt(0)
    s_waitcnt vmcnt(0)
    s_barrier
    s_lshl_b32 s40, s28, 4
    v_add_u32 v2, s40, v0
    s_movk_i32 s41, 0x100
    v_cmp_gt_u32 s[42:43], s41, v2
    v_lshlrev_b32 v2, 7, v2
    v_mov_b32 v3, 1
    s_add_u32 s40, s17, 98304
    s_and_b32 s42, s42, 0xffff
    s_mov_b32 s43, 0
    s_cmp_lg_u32 s19, 0
    s_cbranch_scc1 mega_kernel_sg67
    s_mov_b64 exec, s[42:43]
    buffer_atomic_add v3, v2, s[12:15], s40 offen sc1
    s_mov_b64 exec, -1
mega_kernel_sg67:
    v_mfma_f32_32x32x16_bf16 v[40:55], v[100:103], v[96:99], v[40:55]
    ds_read_b128 v[72:75], v125 offset:16384
    ds_read_b128 v[76:79], v126 offset:16384
    v_mfma_f32_32x32x16_bf16 v[56:71], v[104:107], v[96:99], v[56:71]
    ds_read_b128 v[80:83], v126 offset:17408
    s_waitcnt lgkmcnt(3)
    v_mfma_f32_32x32x16_bf16 v[40:55], v[112:115], v[108:111], v[40:55]
    ds_read_b128 v[84:87], v125 offset:17408
    ds_read_b128 v[88:91], v126 offset:19456
    v_mfma_f32_32x32x16_bf16 v[56:71], v[116:119], v[108:111], v[56:71]
    ds_read_b128 v[92:95], v126 offset:20480
    s_waitcnt lgkmcnt(3)
    v_mfma_f32_32x32x16_bf16 v[40:55], v[76:79], v[72:75], v[40:55]
    ds_read_b128 v[96:99], v125 offset:18432
    ds_read_b128 v[100:103], v126 offset:22528
    v_mfma_f32_32x32x16_bf16 v[56:71], v[80:83], v[72:75], v[56:71]
    ds_read_b128 v[104:107], v126 offset:23552
    s_waitcnt lgkmcnt(3)
    v_mfma_f32_32x32x16_bf16 v[40:55], v[88:91], v[84:87], v[40:55]
    ds_read_b128 v[108:111], v125 offset:19456
    ds_read_b128 v[112:115], v126 offset:25600
    v_mfma_f32_32x32x16_bf16 v[56:71], v[92:95], v[84:87], v[56:71]
    ds_read_b128 v[116:119], v126 offset:26624
    s_waitcnt lgkmcnt(0)
    s_barrier
    v_mfma_f32_32x32x16_bf16 v[40:55], v[100:103], v[96:99], v[40:55]
    ds_read_b128 v[72:75], v125 offset:32768
    ds_read_b128 v[76:79], v126 offset:32768
    v_mfma_f32_32x32x16_bf16 v[56:71], v[104:107], v[96:99], v[56:71]
    ds_read_b128 v[80:83], v126 offset:33792
    s_waitcnt lgkmcnt(3)
    v_mfma_f32_32x32x16_bf16 v[40:55], v[112:115], v[108:111], v[40:55]
    ds_read_b128 v[84:87], v125 offset:33792
    ds_read_b128 v[88:91], v126 offset:35840
    v_mfma_f32_32x32x16_bf16 v[56:71], v[116:119], v[108:111], v[56:71]
    ds_read_b128 v[92:95], v126 offset:36864
    s_waitcnt lgkmcnt(3)
    v_mfma_f32_32x32x16_bf16 v[40:55], v[76:79], v[72:75], v[40:55]
    ds_read_b128 v[96:99], v125 offset:34816
    ds_read_b128 v[100:103], v126 offset:38912
    v_mfma_f32_32x32x16_bf16 v[56:71], v[80:83], v[72:75], v[56:71]
    ds_read_b128 v[104:107], v126 offset:39936
    s_waitcnt lgkmcnt(3)
    v_mfma_f32_32x32x16_bf16 v[40:55], v[88:91], v[84:87], v[40:55]
    ds_read_b128 v[108:111], v125 offset:35840
    ds_read_b128 v[112:115], v126 offset:41984
    v_mfma_f32_32x32x16_bf16 v[56:71], v[92:95], v[84:87], v[56:71]
    ds_read_b128 v[116:119], v126 offset:43008
    s_waitcnt lgkmcnt(0)
    s_barrier
    v_mfma_f32_32x32x16_bf16 v[40:55], v[100:103], v[96:99], v[40:55]
    ds_read_b128 v[72:75], v125 offset:49152
    ds_read_b128 v[76:79], v126 offset:49152
    v_mfma_f32_32x32x16_bf16 v[56:71], v[104:107], v[96:99], v[56:71]
    ds_read_b128 v[80:83], v126 offset:50176
    s_waitcnt lgkmcnt(3)
    v_mfma_f32_32x32x16_bf16 v[40:55], v[112:115], v[108:111], v[40:55]
    ds_read_b128 v[84:87], v125 offset:50176
    ds_read_b128 v[88:91], v126 offset:52224
    v_mfma_f32_32x32x16_bf16 v[56:71], v[116:119], v[108:111], v[56:71]
    ds_read_b128 v[92:95], v126 offset:53248
    s_waitcnt lgkmcnt(3)
    v_mfma_f32_32x32x16_bf16 v[40:55], v[76:79], v[72:75], v[40:55]
    ds_read_b128 v[96:99], v125 offset:51200
    ds_read_b128 v[100:103], v126 offset:55296
    v_mfma_f32_32x32x16_bf16 v[56:71], v[80:83], v[72:75], v[56:71]
    ds_read_b128 v[104:107], v126 offset:56320
    s_waitcnt lgkmcnt(3)
    v_mfma_f32_32x32x16_bf16 v[40:55], v[88:91], v[84:87], v[40:55]
    ds_read_b128 v[108:111], v125 offset:52224
    ds_read_b128 v[112:115], v126 offset:58368
    v_mfma_f32_32x32x16_bf16 v[56:71], v[92:95], v[84:87], v[56:71]
    ds_read_b128 v[116:119], v126 offset:59392
    s_waitcnt lgkmcnt(3)
    v_mfma_f32_32x32x16_bf16 v[40:55], v[100:103], v[96:99], v[40:55]
    v_mfma_f32_32x32x16_bf16 v[56:71], v[104:107], v[96:99], v[56:71]
    s_waitcnt lgkmcnt(0)
    v_mfma_f32_32x32x16_bf16 v[40:55], v[112:115], v[108:111], v[40:55]
    v_mfma_f32_32x32x16_bf16 v[56:71], v[116:119], v[108:111], v[56:71]
    s_nop 10
    v_mul_f32 v134, v40, v40
    v_mul_f32 v135, v41, v41
    v_mul_f32 v136, v42, v42
    v_mul_f32 v137, v43, v43
    v_mul_f32 v138, v44, v44
    v_mul_f32 v139, v45, v45
    v_mul_f32 v140, v46, v46
    v_mul_f32 v141, v47, v47
    v_fma_f32 v134, v134, v124, v123
    v_fma_f32 v135, v135, v124, v123
    v_fma_f32 v136, v136, v124, v123
    v_fma_f32 v137, v137, v124, v123
    v_fma_f32 v138, v138, v124, v123
    v_fma_f32 v139, v139, v124, v123
    v_fma_f32 v140, v140, v124, v123
    v_fma_f32 v141, v141, v124, v123
    v_mul_f32 v134, v134, v40
    v_mul_f32 v135, v135, v41
    v_mul_f32 v136, v136, v42
    v_mul_f32 v137, v137, v43
    v_mul_f32 v138, v138, v44
    v_mul_f32 v139, v139, v45
    v_mul_f32 v140, v140, v46
    v_mul_f32 v141, v141, v47
    v_exp_f32 v134, v134
    v_exp_f32 v135, v135
    v_exp_f32 v136, v136
    v_exp_f32 v137, v137
    v_exp_f32 v138, v138
    v_exp_f32 v139, v139
    v_exp_f32 v140, v140
    v_exp_f32 v141, v141
    v_mul_f32 v40, v40, v48
    v_mul_f32 v41, v41, v49
    v_mul_f32 v42, v42, v50
    v_mul_f32 v43, v43, v51
    v_mul_f32 v44, v44, v52
    v_mul_f32 v45, v45, v53
    v_mul_f32 v46, v46, v54
    v_mul_f32 v47, v47, v55
    v_fma_f32 v134, v134, v122, v122
    v_fma_f32 v135, v135, v122, v122
    v_fma_f32 v136, v136, v122, v122
    v_fma_f32 v137, v137, v122, v122
    v_fma_f32 v138, v138, v122, v122
    v_fma_f32 v139, v139, v122, v122
    v_fma_f32 v140, v140, v122, v122
    v_fma_f32 v141, v141, v122, v122
    v_rcp_f32 v134, v134
    v_rcp_f32 v135, v135
    v_rcp_f32 v136, v136
    v_rcp_f32 v137, v137
    v_rcp_f32 v138, v138
    v_rcp_f32 v139, v139
    v_rcp_f32 v140, v140
    v_rcp_f32 v141, v141
    v_mul_f32 v40, v40, v134
    v_mul_f32 v41, v41, v135
    v_mul_f32 v42, v42, v136
    v_mul_f32 v43, v43, v137
    v_mul_f32 v44, v44, v138
    v_mul_f32 v45, v45, v139
    v_mul_f32 v46, v46, v140
    v_mul_f32 v47, v47, v141
    v_cvt_pk_bf16_f32 v158, v40, v41
    v_cvt_pk_bf16_f32 v159, v42, v43
    v_cvt_pk_bf16_f32 v160, v44, v45
    v_cvt_pk_bf16_f32 v161, v46, v47
    buffer_store_dwordx4 v[158:161], v1, s[12:15], s45 offen offset:0 sc1
    v_mul_f32 v134, v56, v56
    v_mul_f32 v135, v57, v57
    v_mul_f32 v136, v58, v58
    v_mul_f32 v137, v59, v59
    v_mul_f32 v138, v60, v60
    v_mul_f32 v139, v61, v61
    v_mul_f32 v140, v62, v62
    v_mul_f32 v141, v63, v63
    v_fma_f32 v134, v134, v124, v123
    v_fma_f32 v135, v135, v124, v123
    v_fma_f32 v136, v136, v124, v123
    v_fma_f32 v137, v137, v124, v123
    v_fma_f32 v138, v138, v124, v123
    v_fma_f32 v139, v139, v124, v123
    v_fma_f32 v140, v140, v124, v123
    v_fma_f32 v141, v141, v124, v123
    v_mul_f32 v134, v134, v56
    v_mul_f32 v135, v135, v57
    v_mul_f32 v136, v136, v58
    v_mul_f32 v137, v137, v59
    v_mul_f32 v138, v138, v60
    v_mul_f32 v139, v139, v61
    v_mul_f32 v140, v140, v62
    v_mul_f32 v141, v141, v63
    v_exp_f32 v134, v134
    v_exp_f32 v135, v135
    v_exp_f32 v136, v136
    v_exp_f32 v137, v137
    v_exp_f32 v138, v138
    v_exp_f32 v139, v139
    v_exp_f32 v140, v140
    v_exp_f32 v141, v141
    v_mul_f32 v56, v56, v64
    v_mul_f32 v57, v57, v65
    v_mul_f32 v58, v58, v66
    v_mul_f32 v59, v59, v67
    v_mul_f32 v60, v60, v68
    v_mul_f32 v61, v61, v69
    v_mul_f32 v62, v62, v70
    v_mul_f32 v63, v63, v71
    v_fma_f32 v134, v134, v122, v122
    v_fma_f32 v135, v135, v122, v122
    v_fma_f32 v136, v136, v122, v122
    v_fma_f32 v137, v137, v122, v122
    v_fma_f32 v138, v138, v122, v122
    v_fma_f32 v139, v139, v122, v122
    v_fma_f32 v140, v140, v122, v122
    v_fma_f32 v141, v141, v122, v122
    v_rcp_f32 v134, v134
    v_rcp_f32 v135, v135
    v_rcp_f32 v136, v136
    v_rcp_f32 v137, v137
    v_rcp_f32 v138, v138
    v_rcp_f32 v139, v139
    v_rcp_f32 v140, v140
    v_rcp_f32 v141, v141
    v_mul_f32 v56, v56, v134
    v_mul_f32 v57, v57, v135
    v_mul_f32 v58, v58, v136
    v_mul_f32 v59, v59, v137
    v_mul_f32 v60, v60, v138
    v_mul_f32 v61, v61, v139
    v_mul_f32 v62, v62, v140
    v_mul_f32 v63, v63, v141
    v_cvt_pk_bf16_f32 v162, v56, v57
    v_cvt_pk_bf16_f32 v163, v58, v59
    v_cvt_pk_bf16_f32 v164, v60, v61
    v_cvt_pk_bf16_f32 v165, v62, v63
    buffer_store_dwordx4 v[162:165], v1, s[12:15], s45 offen offset:1024 sc1
    s_branch mega_kernel_p4e66
mega_kernel_p4b65:
    s_barrier
    ds_read_b128 v[72:75], v125 offset:0
    ds_read_b128 v[76:79], v126 offset:0
    ds_read_b128 v[80:83], v126 offset:1024
    ds_read_b128 v[84:87], v125 offset:1024
    ds_read_b128 v[88:91], v126 offset:4096
    ds_read_b128 v[92:95], v126 offset:5120
    s_waitcnt lgkmcnt(3)
    v_mfma_f32_32x32x16_bf16 v[8:23], v[76:79], v[72:75], v[8:23]
    ds_read_b128 v[96:99], v125 offset:2048
    ds_read_b128 v[100:103], v126 offset:8192
    v_mfma_f32_32x32x16_bf16 v[24:39], v[80:83], v[72:75], v[24:39]
    ds_read_b128 v[104:107], v126 offset:9216
    s_waitcnt lgkmcnt(3)
    v_mfma_f32_32x32x16_bf16 v[8:23], v[88:91], v[84:87], v[8:23]
    ds_read_b128 v[108:111], v125 offset:3072
    ds_read_b128 v[112:115], v126 offset:12288
    v_mfma_f32_32x32x16_bf16 v[24:39], v[92:95], v[84:87], v[24:39]
    ds_read_b128 v[116:119], v126 offset:13312
    s_waitcnt lgkmcnt(3)
    s_barrier
    v_mfma_f32_32x32x16_bf16 v[8:23], v[100:103], v[96:99], v[8:23]
    ds_read_b128 v[72:75], v125 offset:16384
    ds_read_b128 v[76:79], v126 offset:16384
    v_mfma_f32_32x32x16_bf16 v[24:39], v[104:107], v[96:99], v[24:39]
    ds_read_b128 v[80:83], v126 offset:17408
    s_waitcnt lgkmcnt(3)
    v_mfma_f32_32x32x16_bf16 v[8:23], v[112:115], v[108:111], v[8:23]
    ds_read_b128 v[84:87], v125 offset:17408
    ds_read_b128 v[88:91], v126 offset:20480
    v_mfma_f32_32x32x16_bf16 v[24:39], v[116:119], v[108:111], v[24:39]
    ds_read_b128 v[92:95], v126 offset:21504
    s_waitcnt lgkmcnt(3)
    v_mfma_f32_32x32x16_bf16 v[8:23], v[76:79], v[72:75], v[8:23]
    ds_read_b128 v[96:99], v125 offset:18432
    ds_read_b128 v[100:103], v126 offset:24576
    v_mfma_f32_32x32x16_bf16 v[24:39], v[80:83], v[72:75], v[24:39]
    ds_read_b128 v[104:107], v126 offset:25600
    s_waitcnt lgkmcnt(3)
    v_mfma_f32_32x32x16_bf16 v[8:23], v[88:91], v[84:87], v[8:23]
    ds_read_b128 v[108:111], v125 offset:19456
    ds_read_b128 v[112:115], v126 offset:28672
    v_mfma_f32_32x32x16_bf16 v[24:39], v[92:95], v[84:87], v[24:39]
    ds_read_b128 v[116:119], v126 offset:29696
    s_waitcnt lgkmcnt(3)
    s_barrier
    v_mfma_f32_32x32x16_bf16 v[8:23], v[100:103], v[96:99], v[8:23]
    ds_read_b128 v[72:75], v125 offset:32768
    ds_read_b128 v[76:79], v126 offset:32768
    v_mfma_f32_32x32x16_bf16 v[24:39], v[104:107], v[96:99], v[24:39]
    ds_read_b128 v[80:83], v126 offset:33792
    s_waitcnt lgkmcnt(3)
    v_mfma_f32_32x32x16_bf16 v[8:23], v[112:115], v[108:111], v[8:23]
    ds_read_b128 v[84:87], v125 offset:33792
    ds_read_b128 v[88:91], v126 offset:36864
    v_mfma_f32_32x32x16_bf16 v[24:39], v[116:119], v[108:111], v[24:39]
    ds_read_b128 v[92:95], v126 offset:37888
    s_waitcnt lgkmcnt(3)
    v_mfma_f32_32x32x16_bf16 v[8:23], v[76:79], v[72:75], v[8:23]
    ds_read_b128 v[96:99], v125 offset:34816
    ds_read_b128 v[100:103], v126 offset:40960
    v_mfma_f32_32x32x16_bf16 v[24:39], v[80:83], v[72:75], v[24:39]
    ds_read_b128 v[104:107], v126 offset:41984
    s_waitcnt lgkmcnt(3)
    v_mfma_f32_32x32x16_bf16 v[8:23], v[88:91], v[84:87], v[8:23]
    ds_read_b128 v[108:111], v125 offset:35840
    ds_read_b128 v[112:115], v126 offset:45056
    v_mfma_f32_32x32x16_bf16 v[24:39], v[92:95], v[84:87], v[24:39]
    ds_read_b128 v[116:119], v126 offset:46080
    s_waitcnt lgkmcnt(3)
    s_barrier
    v_mfma_f32_32x32x16_bf16 v[8:23], v[100:103], v[96:99], v[8:23]
    ds_read_b128 v[72:75], v125 offset:49152
    ds_read_b128 v[76:79], v126 offset:49152
    v_mfma_f32_32x32x16_bf16 v[24:39], v[104:107], v[96:99], v[24:39]
    ds_read_b128 v[80:83], v126 offset:50176
    s_waitcnt lgkmcnt(3)
    v_mfma_f32_32x32x16_bf16 v[8:23], v[112:115], v[108:111], v[8:23]
    ds_read_b128 v[84:87], v125 offset:50176
    ds_read_b128 v[88:91], v126 offset:53248
    v_mfma_f32_32x32x16_bf16 v[24:39], v[116:119], v[108:111], v[24:39]
    ds_read_b128 v[92:95], v126 offset:54272
    s_waitcnt lgkmcnt(3)
    v_mfma_f32_32x32x16_bf16 v[8:23], v[76:79], v[72:75], v[8:23]
    ds_read_b128 v[96:99], v125 offset:51200
    ds_read_b128 v[100:103], v126 offset:57344
    v_mfma_f32_32x32x16_bf16 v[24:39], v[80:83], v[72:75], v[24:39]
    ds_read_b128 v[104:107], v126 offset:58368
    ds_read_b128 v[142:145], v2 offset:0
    ds_read_b128 v[146:149], v2 offset:512
    ds_read_b128 v[150:153], v2 offset:1024
    ds_read_b128 v[154:157], v2 offset:1536
    s_waitcnt lgkmcnt(0)
    v_mfma_f32_32x32x16_bf16 v[8:23], v[88:91], v[84:87], v[8:23]
    ds_read_b128 v[108:111], v125 offset:52224
    ds_read_b128 v[112:115], v126 offset:61440
    v_mfma_f32_32x32x16_bf16 v[24:39], v[92:95], v[84:87], v[24:39]
    ds_read_b128 v[116:119], v126 offset:62464
    v_add_f32 v134, v142, v144
    v_add_f32 v135, v143, v145
    v_add_f32 v134, v134, v146
    v_add_f32 v135, v135, v147
    v_add_f32 v134, v134, v148
    v_add_f32 v135, v135, v149
    v_add_f32 v134, v134, v150
    v_add_f32 v135, v135, v151
    v_add_f32 v134, v134, v152
    v_add_f32 v135, v135, v153
    v_add_f32 v134, v134, v154
    v_add_f32 v135, v135, v155
    v_add_f32 v134, v134, v156
    v_add_f32 v135, v135, v157
    v_mov_b32 v136, v134
    v_mov_b32 v137, v135
    s_nop 0
    v_permlane32_swap_b32 v136, v134
    v_permlane32_swap_b32 v137, v135
    v_add_f32 v134, v134, v136
    v_add_f32 v135, v135, v137
    v_mul_f32 v134, 0x3b000000, v134
    v_mul_f32 v135, 0x3b000000, v135
    v_fma_f32 v135, -v134, v134, v135
    v_max_f32 v135, 0, v135
    v_cvt_pk_bf16_f32 v120, v134, v134
    v_lshlrev_b32 v120, 16, v120
    v_cvt_pk_bf16_f32 v136, v135, v135
    v_lshlrev_b32 v136, 16, v136
    v_add_f32 v136, 0x3727c5ac, v136
    v_cvt_pk_bf16_f32 v136, v136, v136
    v_lshlrev_b32 v136, 16, v136
    v_sqrt_f32 v136, v136
    s_nop 0
    v_cvt_pk_bf16_f32 v136, v136, v136
    v_lshlrev_b32 v136, 16, v136
    v_rcp_f32 v121, v136
    v_mul_f32 v122, v136, v136
    v_mul_f32 v123, 0xc0135761, v121
    v_mul_f32 v124, v121, v121
    v_mul_f32 v124, v124, v123
    v_mul_f32 v124, 0x3d372713, v124
    v_mov_b32 v130, 0
    v_mov_b32 v131, 0
    v_mov_b32 v132, 0
    v_mov_b32 v133, 0
    s_mov_b32 exec_hi, 0
    v_xor_b32 v130, 0x80000000, v120
    v_lshrrev_b32 v131, 16, v130
    v_or_b32 v130, v130, v131
    s_mov_b32 exec_hi, -1
    s_waitcnt lgkmcnt(3)
    s_barrier
    v_mfma_f32_32x32x16_bf16 v[8:23], v[100:103], v[96:99], v[8:23]
    ds_read_b128 v[72:75], v125 offset:0
    ds_read_b128 v[76:79], v126 offset:0
    v_mfma_f32_32x32x16_bf16 v[24:39], v[104:107], v[96:99], v[24:39]
    ds_read_b128 v[80:83], v126 offset:1024
    s_waitcnt lgkmcnt(3)
    v_mfma_f32_32x32x16_bf16 v[8:23], v[112:115], v[108:111], v[8:23]
    ds_read_b128 v[84:87], v125 offset:1024
    ds_read_b128 v[88:91], v126 offset:4096
    v_mfma_f32_32x32x16_bf16 v[24:39], v[116:119], v[108:111], v[24:39]
    ds_read_b128 v[92:95], v126 offset:5120
    s_waitcnt lgkmcnt(3)
    v_mfma_f32_32x32x16_bf16 v[8:23], v[76:79], v[72:75], v[8:23]
    ds_read_b128 v[96:99], v125 offset:2048
    ds_read_b128 v[100:103], v126 offset:8192
    v_mfma_f32_32x32x16_bf16 v[24:39], v[80:83], v[72:75], v[24:39]
    ds_read_b128 v[104:107], v126 offset:9216
    ds_read_b128 v[142:145], v128 offset:0
    ds_read_b128 v[146:149], v128 offset:512
    s_waitcnt lgkmcnt(3)
    v_mfma_f32_32x32x16_bf16 v[8:23], v[88:91], v[84:87], v[8:23]
    ds_read_b128 v[108:111], v125 offset:3072
    ds_read_b128 v[112:115], v126 offset:12288
    v_mfma_f32_32x32x16_bf16 v[24:39], v[92:95], v[84:87], v[24:39]
    ds_read_b128 v[116:119], v126 offset:13312
    s_waitcnt lgkmcnt(0)
    s_barrier
    v_mfma_f32_32x32x16_bf16 v[8:23], v[100:103], v[96:99], v[8:23]
    ds_read_b128 v[72:75], v125 offset:16384
    ds_read_b128 v[76:79], v126 offset:16384
    v_mfma_f32_32x32x16_bf16 v[24:39], v[104:107], v[96:99], v[24:39]
    ds_read_b128 v[80:83], v126 offset:17408
    v_mfma_f32_32x32x16_bf16 v[8:23], v[142:145], v[130:133], v[8:23]
    v_mfma_f32_32x32x16_bf16 v[24:39], v[146:149], v[130:133], v[24:39]
    s_waitcnt lgkmcnt(3)
    v_mfma_f32_32x32x16_bf16 v[8:23], v[112:115], v[108:111], v[8:23]
    ds_read_b128 v[84:87], v125 offset:17408
    ds_read_b128 v[88:91], v126 offset:20480
    v_mfma_f32_32x32x16_bf16 v[24:39], v[116:119], v[108:111], v[24:39]
    ds_read_b128 v[92:95], v126 offset:21504
    s_waitcnt lgkmcnt(3)
    v_mfma_f32_32x32x16_bf16 v[8:23], v[76:79], v[72:75], v[8:23]
    ds_read_b128 v[96:99], v125 offset:18432
    ds_read_b128 v[100:103], v126 offset:24576
    v_mfma_f32_32x32x16_bf16 v[24:39], v[80:83], v[72:75], v[24:39]
    ds_read_b128 v[104:107], v126 offset:25600
    s_waitcnt lgkmcnt(3)
    v_mfma_f32_32x32x16_bf16 v[8:23], v[88:91], v[84:87], v[8:23]
    ds_read_b128 v[108:111], v125 offset:19456
    ds_read_b128 v[112:115], v126 offset:28672
    v_mfma_f32_32x32x16_bf16 v[24:39], v[92:95], v[84:87], v[24:39]
    ds_read_b128 v[116:119], v126 offset:29696
    s_waitcnt lgkmcnt(0)
    s_barrier
    v_mfma_f32_32x32x16_bf16 v[8:23], v[100:103], v[96:99], v[8:23]
    ds_read_b128 v[72:75], v125 offset:32768
    ds_read_b128 v[76:79], v126 offset:32768
    v_mfma_f32_32x32x16_bf16 v[24:39], v[104:107], v[96:99], v[24:39]
    ds_read_b128 v[80:83], v126 offset:33792
    s_waitcnt lgkmcnt(3)
    v_mfma_f32_32x32x16_bf16 v[8:23], v[112:115], v[108:111], v[8:23]
    ds_read_b128 v[84:87], v125 offset:33792
    ds_read_b128 v[88:91], v126 offset:36864
    v_mfma_f32_32x32x16_bf16 v[24:39], v[116:119], v[108:111], v[24:39]
    ds_read_b128 v[92:95], v126 offset:37888
    s_waitcnt lgkmcnt(3)
    v_mfma_f32_32x32x16_bf16 v[8:23], v[76:79], v[72:75], v[8:23]
    ds_read_b128 v[96:99], v125 offset:34816
    ds_read_b128 v[100:103], v126 offset:40960
    v_mfma_f32_32x32x16_bf16 v[24:39], v[80:83], v[72:75], v[24:39]
    ds_read_b128 v[104:107], v126 offset:41984
    s_waitcnt lgkmcnt(3)
    v_mfma_f32_32x32x16_bf16 v[8:23], v[88:91], v[84:87], v[8:23]
    ds_read_b128 v[108:111], v125 offset:35840
    ds_read_b128 v[112:115], v126 offset:45056
    v_mfma_f32_32x32x16_bf16 v[24:39], v[92:95], v[84:87], v[24:39]
    ds_read_b128 v[116:119], v126 offset:46080
    s_waitcnt lgkmcnt(0)
    s_barrier
    v_mfma_f32_32x32x16_bf16 v[8:23], v[100:103], v[96:99], v[8:23]
    ds_read_b128 v[72:75], v125 offset:49152
    ds_read_b128 v[76:79], v126 offset:49152
    v_mfma_f32_32x32x16_bf16 v[24:39], v[104:107], v[96:99], v[24:39]
    ds_read_b128 v[80:83], v126 offset:50176
    s_waitcnt lgkmcnt(3)
    v_mfma_f32_32x32x16_bf16 v[8:23], v[112:115], v[108:111], v[8:23]
    ds_read_b128 v[84:87], v125 offset:50176
    ds_read_b128 v[88:91], v126 offset:53248
    v_mfma_f32_32x32x16_bf16 v[24:39], v[116:119], v[108:111], v[24:39]
    ds_read_b128 v[92:95], v126 offset:54272
    s_waitcnt lgkmcnt(3)
    v_mfma_f32_32x32x16_bf16 v[8:23], v[76:79], v[72:75], v[8:23]
    ds_read_b128 v[96:99], v125 offset:51200
    ds_read_b128 v[100:103], v126 offset:57344
    v_mfma_f32_32x32x16_bf16 v[24:39], v[80:83], v[72:75], v[24:39]
    ds_read_b128 v[104:107], v126 offset:58368
    s_waitcnt lgkmcnt(3)
    v_mfma_f32_32x32x16_bf16 v[8:23], v[88:91], v[84:87], v[8:23]
    ds_read_b128 v[108:111], v125 offset:52224
    ds_read_b128 v[112:115], v126 offset:61440
    v_mfma_f32_32x32x16_bf16 v[24:39], v[92:95], v[84:87], v[24:39]
    ds_read_b128 v[116:119], v126 offset:62464
    s_waitcnt lgkmcnt(0)
    s_barrier
    v_mfma_f32_32x32x16_bf16 v[8:23], v[100:103], v[96:99], v[8:23]
    ds_read_b128 v[72:75], v125 offset:0
    v_mfma_f32_32x32x16_bf16 v[24:39], v[104:107], v[96:99], v[24:39]
    ds_read_b128 v[76:79], v126 offset:0
    s_waitcnt lgkmcnt(2)
    v_mfma_f32_32x32x16_bf16 v[8:23], v[112:115], v[108:111], v[8:23]
    ds_read_b128 v[84:87], v125 offset:1024
    v_mfma_f32_32x32x16_bf16 v[24:39], v[116:119], v[108:111], v[24:39]
    ds_read_b128 v[88:91], v126 offset:3072
    s_waitcnt lgkmcnt(2)
    v_mfma_f32_32x32x16_bf16 v[40:55], v[76:79], v[72:75], v[40:55]
    ds_read_b128 v[96:99], v125 offset:2048
    ds_read_b128 v[100:103], v126 offset:6144
    s_waitcnt lgkmcnt(2)
    v_mfma_f32_32x32x16_bf16 v[40:55], v[88:91], v[84:87], v[40:55]
    ds_read_b128 v[108:111], v125 offset:3072
    ds_read_b128 v[112:115], v126 offset:9216
    s_nop 0
    v_mul_f32 v134, v8, v8
    v_mul_f32 v135, v9, v9
    v_mul_f32 v136, v10, v10
    v_mul_f32 v137, v11, v11
    v_mul_f32 v138, v12, v12
    v_mul_f32 v139, v13, v13
    v_mul_f32 v140, v14, v14
    v_mul_f32 v141, v15, v15
    v_fma_f32 v134, v134, v124, v123
    v_fma_f32 v135, v135, v124, v123
    v_fma_f32 v136, v136, v124, v123
    v_fma_f32 v137, v137, v124, v123
    v_fma_f32 v138, v138, v124, v123
    v_fma_f32 v139, v139, v124, v123
    s_waitcnt lgkmcnt(0)
    s_barrier
    v_mfma_f32_32x32x16_bf16 v[40:55], v[100:103], v[96:99], v[40:55]
    ds_read_b128 v[72:75], v125 offset:16384
    ds_read_b128 v[76:79], v126 offset:16384
    v_fma_f32 v140, v140, v124, v123
    v_fma_f32 v141, v141, v124, v123
    v_mul_f32 v134, v134, v8
    v_mul_f32 v135, v135, v9
    v_mul_f32 v136, v136, v10
    v_mul_f32 v137, v137, v11
    v_mul_f32 v138, v138, v12
    v_mul_f32 v139, v139, v13
    v_mul_f32 v140, v140, v14
    v_mul_f32 v141, v141, v15
    v_exp_f32 v134, v134
    v_exp_f32 v135, v135
    v_exp_f32 v136, v136
    v_exp_f32 v137, v137
    s_waitcnt lgkmcnt(2)
    v_mfma_f32_32x32x16_bf16 v[40:55], v[112:115], v[108:111], v[40:55]
    ds_read_b128 v[84:87], v125 offset:17408
    ds_read_b128 v[88:91], v126 offset:19456
    v_exp_f32 v138, v138
    v_exp_f32 v139, v139
    v_exp_f32 v140, v140
    v_exp_f32 v141, v141
    v_mul_f32 v8, v8, v16
    v_mul_f32 v9, v9, v17
    v_mul_f32 v10, v10, v18
    v_mul_f32 v11, v11, v19
    v_mul_f32 v12, v12, v20
    v_mul_f32 v13, v13, v21
    v_mul_f32 v14, v14, v22
    v_mul_f32 v15, v15, v23
    v_fma_f32 v134, v134, v122, v122
    v_fma_f32 v135, v135, v122, v122
    s_waitcnt lgkmcnt(2)
    v_mfma_f32_32x32x16_bf16 v[40:55], v[76:79], v[72:75], v[40:55]
    ds_read_b128 v[96:99], v125 offset:18432
    ds_read_b128 v[100:103], v126 offset:22528
    v_fma_f32 v136, v136, v122, v122
    v_fma_f32 v137, v137, v122, v122
    v_fma_f32 v138, v138, v122, v122
    v_fma_f32 v139, v139, v122, v122
    v_fma_f32 v140, v140, v122, v122
    v_fma_f32 v141, v141, v122, v122
    v_rcp_f32 v134, v134
    v_rcp_f32 v135, v135
    v_rcp_f32 v136, v136
    v_rcp_f32 v137, v137
    v_rcp_f32 v138, v138
    v_rcp_f32 v139, v139
    v_rcp_f32 v140, v140
    v_rcp_f32 v141, v141
    ds_read_b128 v[142:145], v128 offset:2048
    s_waitcnt lgkmcnt(2)
    v_mfma_f32_32x32x16_bf16 v[40:55], v[88:91], v[84:87], v[40:55]
    ds_read_b128 v[108:111], v125 offset:19456
    ds_read_b128 v[112:115], v126 offset:25600
    v_mul_f32 v8, v8, v134
    v_mul_f32 v9, v9, v135
    v_mul_f32 v10, v10, v136
    v_mul_f32 v11, v11, v137
    v_mul_f32 v12, v12, v138
    v_mul_f32 v13, v13, v139
    v_mul_f32 v14, v14, v140
    v_mul_f32 v15, v15, v141
    v_cvt_pk_bf16_f32 v158, v8, v9
    v_cvt_pk_bf16_f32 v159, v10, v11
    v_cvt_pk_bf16_f32 v160, v12, v13
    v_cvt_pk_bf16_f32 v161, v14, v15
    buffer_store_dwordx4 v[158:161], v1, s[12:15], s44 offen offset:0 sc1
    v_mul_f32 v134, v24, v24
    s_waitcnt lgkmcnt(0)
    s_barrier
    v_mfma_f32_32x32x16_bf16 v[40:55], v[100:103], v[96:99], v[40:55]
    ds_read_b128 v[72:75], v125 offset:32768
    ds_read_b128 v[76:79], v126 offset:32768
    v_mul_f32 v135, v25, v25
    v_mul_f32 v136, v26, v26
    v_mul_f32 v137, v27, v27
    v_mul_f32 v138, v28, v28
    v_mul_f32 v139, v29, v29
    v_mul_f32 v140, v30, v30
    v_mul_f32 v141, v31, v31
    v_fma_f32 v134, v134, v124, v123
    v_fma_f32 v135, v135, v124, v123
    v_fma_f32 v136, v136, v124, v123
    v_fma_f32 v137, v137, v124, v123
    v_fma_f32 v138, v138, v124, v123
    v_fma_f32 v139, v139, v124, v123
    v_fma_f32 v140, v140, v124, v123
    v_mfma_f32_32x32x16_bf16 v[40:55], v[142:145], v[130:133], v[40:55]
    s_waitcnt lgkmcnt(2)
    v_mfma_f32_32x32x16_bf16 v[40:55], v[112:115], v[108:111], v[40:55]
    ds_read_b128 v[84:87], v125 offset:33792
    ds_read_b128 v[88:91], v126 offset:35840
    v_fma_f32 v141, v141, v124, v123
    v_mul_f32 v134, v134, v24
    v_mul_f32 v135, v135, v25
    v_mul_f32 v136, v136, v26
    v_mul_f32 v137, v137, v27
    v_mul_f32 v138, v138, v28
    v_mul_f32 v139, v139, v29
    v_mul_f32 v140, v140, v30
    v_mul_f32 v141, v141, v31
    v_exp_f32 v134, v134
    v_exp_f32 v135, v135
    v_exp_f32 v136, v136
    v_exp_f32 v137, v137
    v_exp_f32 v138, v138
    s_waitcnt lgkmcnt(2)
    v_mfma_f32_32x32x16_bf16 v[40:55], v[76:79], v[72:75], v[40:55]
    ds_read_b128 v[96:99], v125 offset:34816
    ds_read_b128 v[100:103], v126 offset:38912
    v_exp_f32 v139, v139
    v_exp_f32 v140, v140
    v_exp_f32 v141, v141
    v_mul_f32 v24, v24, v32
    v_mul_f32 v25, v25, v33
    v_mul_f32 v26, v26, v34
    v_mul_f32 v27, v27, v35
    v_mul_f32 v28, v28, v36
    v_mul_f32 v29, v29, v37
    v_mul_f32 v30, v30, v38
    v_mul_f32 v31, v31, v39
    v_fma_f32 v134, v134, v122, v122
    v_fma_f32 v135, v135, v122, v122
    v_fma_f32 v136, v136, v122, v122
    s_waitcnt lgkmcnt(2)
    v_mfma_f32_32x32x16_bf16 v[40:55], v[88:91], v[84:87], v[40:55]
    ds_read_b128 v[108:111], v125 offset:35840
    ds_read_b128 v[112:115], v126 offset:41984
    v_fma_f32 v137, v137, v122, v122
    v_fma_f32 v138, v138, v122, v122
    v_fma_f32 v139, v139, v122, v122
    v_fma_f32 v140, v140, v122, v122
    v_fma_f32 v141, v141, v122, v122
    v_rcp_f32 v134, v134
    v_rcp_f32 v135, v135
    v_rcp_f32 v136, v136
    v_rcp_f32 v137, v137
    v_rcp_f32 v138, v138
    v_rcp_f32 v139, v139
    v_rcp_f32 v140, v140
    v_rcp_f32 v141, v141
    v_mul_f32 v24, v24, v134
    s_waitcnt lgkmcnt(0)
    s_barrier
    v_mfma_f32_32x32x16_bf16 v[40:55], v[100:103], v[96:99], v[40:55]
    ds_read_b128 v[72:75], v125 offset:49152
    ds_read_b128 v[76:79], v126 offset:49152
    v_mul_f32 v25, v25, v135
    v_mul_f32 v26, v26, v136
    v_mul_f32 v27, v27, v137
    v_mul_f32 v28, v28, v138
    v_mul_f32 v29, v29, v139
    v_mul_f32 v30, v30, v140
    v_mul_f32 v31, v31, v141
    v_cvt_pk_bf16_f32 v162, v24, v25
    v_cvt_pk_bf16_f32 v163, v26, v27
    v_cvt_pk_bf16_f32 v164, v28, v29
    v_cvt_pk_bf16_f32 v165, v30, v31
    buffer_store_dwordx4 v[162:165], v1, s[12:15], s44 offen offset:1024 sc1
    s_waitcnt lgkmcnt(2)
    v_mfma_f32_32x32x16_bf16 v[40:55], v[112:115], v[108:111], v[40:55]
    ds_read_b128 v[84:87], v125 offset:50176
    ds_read_b128 v[88:91], v126 offset:52224
    s_waitcnt lgkmcnt(2)
    v_mfma_f32_32x32x16_bf16 v[40:55], v[76:79], v[72:75], v[40:55]
    ds_read_b128 v[96:99], v125 offset:51200
    ds_read_b128 v[100:103], v126 offset:55296
    s_waitcnt lgkmcnt(2)
    v_mfma_f32_32x32x16_bf16 v[40:55], v[88:91], v[84:87], v[40:55]
    ds_read_b128 v[108:111], v125 offset:52224
    ds_read_b128 v[112:115], v126 offset:58368
    s_waitcnt lgkmcnt(0)
    s_barrier
    v_mfma_f32_32x32x16_bf16 v[40:55], v[100:103], v[96:99], v[40:55]
    ds_read_b128 v[72:75], v125 offset:0
    ds_read_b128 v[76:79], v126 offset:0
    s_waitcnt lgkmcnt(2)
    v_mfma_f32_32x32x16_bf16 v[40:55], v[112:115], v[108:111], v[40:55]
    ds_read_b128 v[84:87], v125 offset:1024
    ds_read_b128 v[88:91], v126 offset:3072
    s_waitcnt lgkmcnt(2)
    v_mfma_f32_32x32x16_bf16 v[40:55], v[76:79], v[72:75], v[40:55]
    ds_read_b128 v[96:99], v125 offset:2048
    ds_read_b128 v[100:103], v126 offset:6144
    s_waitcnt lgkmcnt(2)
    v_mfma_f32_32x32x16_bf16 v[40:55], v[88:91], v[84:87], v[40:55]
    ds_read_b128 v[108:111], v125 offset:3072
    ds_read_b128 v[112:115], v126 offset:9216
    s_waitcnt lgkmcnt(0)
    s_waitcnt vmcnt(0)
    s_barrier
    s_lshl_b32 s40, s28, 4
    v_add_u32 v2, s40, v0
    s_movk_i32 s41, 0x100
    v_cmp_gt_u32 s[42:43], s41, v2
    v_lshlrev_b32 v2, 7, v2
    v_mov_b32 v3, 1
    s_add_u32 s40, s17, 98304
    s_and_b32 s42, s42, 0xffff
    s_mov_b32 s43, 0
    s_cmp_lg_u32 s19, 0
    s_cbranch_scc1 mega_kernel_sg68
    s_mov_b64 exec, s[42:43]
    buffer_atomic_add v3, v2, s[12:15], s40 offen sc1
    s_mov_b64 exec, -1
mega_kernel_sg68:
    v_mfma_f32_32x32x16_bf16 v[40:55], v[100:103], v[96:99], v[40:55]
    ds_read_b128 v[72:75], v125 offset:16384
    ds_read_b128 v[76:79], v126 offset:16384
    s_waitcnt lgkmcnt(2)
    v_mfma_f32_32x32x16_bf16 v[40:55], v[112:115], v[108:111], v[40:55]
    ds_read_b128 v[84:87], v125 offset:17408
    ds_read_b128 v[88:91], v126 offset:19456
    s_waitcnt lgkmcnt(2)
    v_mfma_f32_32x32x16_bf16 v[40:55], v[76:79], v[72:75], v[40:55]
    ds_read_b128 v[96:99], v125 offset:18432
    ds_read_b128 v[100:103], v126 offset:22528
    s_waitcnt lgkmcnt(2)
    v_mfma_f32_32x32x16_bf16 v[40:55], v[88:91], v[84:87], v[40:55]
    ds_read_b128 v[108:111], v125 offset:19456
    ds_read_b128 v[112:115], v126 offset:25600
    s_waitcnt lgkmcnt(0)
    s_barrier
    v_mfma_f32_32x32x16_bf16 v[40:55], v[100:103], v[96:99], v[40:55]
    ds_read_b128 v[72:75], v125 offset:32768
    ds_read_b128 v[76:79], v126 offset:32768
    s_waitcnt lgkmcnt(2)
    v_mfma_f32_32x32x16_bf16 v[40:55], v[112:115], v[108:111], v[40:55]
    ds_read_b128 v[84:87], v125 offset:33792
    ds_read_b128 v[88:91], v126 offset:35840
    s_waitcnt lgkmcnt(2)
    v_mfma_f32_32x32x16_bf16 v[40:55], v[76:79], v[72:75], v[40:55]
    ds_read_b128 v[96:99], v125 offset:34816
    ds_read_b128 v[100:103], v126 offset:38912
    s_waitcnt lgkmcnt(2)
    v_mfma_f32_32x32x16_bf16 v[40:55], v[88:91], v[84:87], v[40:55]
    ds_read_b128 v[108:111], v125 offset:35840
    ds_read_b128 v[112:115], v126 offset:41984
    s_waitcnt lgkmcnt(0)
    s_barrier
    v_mfma_f32_32x32x16_bf16 v[40:55], v[100:103], v[96:99], v[40:55]
    ds_read_b128 v[72:75], v125 offset:49152
    ds_read_b128 v[76:79], v126 offset:49152
    s_waitcnt lgkmcnt(2)
    v_mfma_f32_32x32x16_bf16 v[40:55], v[112:115], v[108:111], v[40:55]
    ds_read_b128 v[84:87], v125 offset:50176
    ds_read_b128 v[88:91], v126 offset:52224
    s_waitcnt lgkmcnt(2)
    v_mfma_f32_32x32x16_bf16 v[40:55], v[76:79], v[72:75], v[40:55]
    ds_read_b128 v[96:99], v125 offset:51200
    ds_read_b128 v[100:103], v126 offset:55296
    s_waitcnt lgkmcnt(2)
    v_mfma_f32_32x32x16_bf16 v[40:55], v[88:91], v[84:87], v[40:55]
    ds_read_b128 v[108:111], v125 offset:52224
    ds_read_b128 v[112:115], v126 offset:58368
    s_waitcnt lgkmcnt(2)
    v_mfma_f32_32x32x16_bf16 v[40:55], v[100:103], v[96:99], v[40:55]
    s_waitcnt lgkmcnt(0)
    v_mfma_f32_32x32x16_bf16 v[40:55], v[112:115], v[108:111], v[40:55]
    s_nop 11
    v_mul_f32 v134, v40, v40
    v_mul_f32 v135, v41, v41
    v_mul_f32 v136, v42, v42
    v_mul_f32 v137, v43, v43
    v_mul_f32 v138, v44, v44
    v_mul_f32 v139, v45, v45
    v_mul_f32 v140, v46, v46
    v_mul_f32 v141, v47, v47
    v_fma_f32 v134, v134, v124, v123
    v_fma_f32 v135, v135, v124, v123
    v_fma_f32 v136, v136, v124, v123
    v_fma_f32 v137, v137, v124, v123
    v_fma_f32 v138, v138, v124, v123
    v_fma_f32 v139, v139, v124, v123
    v_fma_f32 v140, v140, v124, v123
    v_fma_f32 v141, v141, v124, v123
    v_mul_f32 v134, v134, v40
    v_mul_f32 v135, v135, v41
    v_mul_f32 v136, v136, v42
    v_mul_f32 v137, v137, v43
    v_mul_f32 v138, v138, v44
    v_mul_f32 v139, v139, v45
    v_mul_f32 v140, v140, v46
    v_mul_f32 v141, v141, v47
    v_exp_f32 v134, v134
    v_exp_f32 v135, v135
    v_exp_f32 v136, v136
    v_exp_f32 v137, v137
    v_exp_f32 v138, v138
    v_exp_f32 v139, v139
    v_exp_f32 v140, v140
    v_exp_f32 v141, v141
    v_mul_f32 v40, v40, v48
    v_mul_f32 v41, v41, v49
    v_mul_f32 v42, v42, v50
    v_mul_f32 v43, v43, v51
    v_mul_f32 v44, v44, v52
    v_mul_f32 v45, v45, v53
    v_mul_f32 v46, v46, v54
    v_mul_f32 v47, v47, v55
    v_fma_f32 v134, v134, v122, v122
    v_fma_f32 v135, v135, v122, v122
    v_fma_f32 v136, v136, v122, v122
    v_fma_f32 v137, v137, v122, v122
    v_fma_f32 v138, v138, v122, v122
    v_fma_f32 v139, v139, v122, v122
    v_fma_f32 v140, v140, v122, v122
    v_fma_f32 v141, v141, v122, v122
    v_rcp_f32 v134, v134
    v_rcp_f32 v135, v135
    v_rcp_f32 v136, v136
    v_rcp_f32 v137, v137
    v_rcp_f32 v138, v138
    v_rcp_f32 v139, v139
    v_rcp_f32 v140, v140
    v_rcp_f32 v141, v141
    v_mul_f32 v40, v40, v134
    v_mul_f32 v41, v41, v135
    v_mul_f32 v42, v42, v136
    v_mul_f32 v43, v43, v137
    v_mul_f32 v44, v44, v138
    v_mul_f32 v45, v45, v139
    v_mul_f32 v46, v46, v140
    v_mul_f32 v47, v47, v141
    v_cvt_pk_bf16_f32 v158, v40, v41
    v_cvt_pk_bf16_f32 v159, v42, v43
    v_cvt_pk_bf16_f32 v160, v44, v45
    v_cvt_pk_bf16_f32 v161, v46, v47
    buffer_store_dwordx4 v[158:161], v1, s[12:15], s45 offen offset:0 sc1
mega_kernel_p4e66:
    s_cmp_lg_u32 s19, 0
    s_cbranch_scc1 mega_kernel_ew69
    v_mov_b32 v2, 151552
    ds_write_b32 v2, v2
mega_kernel_ew69:
    s_lshl_b32 s40, s28, 4
    v_add_u32 v2, s40, v0
    s_movk_i32 s41, 0x100
    v_cmp_gt_u32 s[42:43], s41, v2
    v_lshlrev_b32 v2, 7, v2
    v_mov_b32 v3, 1
    s_add_u32 s40, s17, 163840
    s_and_b32 s42, s42, 0xffff
    s_mov_b32 s43, 0
    s_waitcnt vmcnt(0) lgkmcnt(0)
    s_barrier
    s_cmp_lg_u32 s19, 0
    s_cbranch_scc1 mega_kernel_sg70
    s_mov_b64 exec, s[42:43]
    buffer_atomic_add v3, v2, s[12:15], s40 offen sc1
    s_mov_b64 exec, -1
mega_kernel_sg70:
    s_cmp_ge_u32 s19, 4
    s_cbranch_scc1 mega_kernel_p3idle76
    s_and_b32 s35, s19, 1
    s_lshr_b32 s36, s19, 1
    s_lshl_b32 s37, s20, 1
    s_add_u32 s37, s37, s35
    s_lshl_b32 s38, s35, 13
    v_add_u32 v98, s38, v1
    s_lshl_b32 s39, s36, 10
    v_add_u32 v101, s39, v1
    v_add_u32 v99, 65536, v98
    v_add_u32 v102, 65536, v101
    v_add_u32 v100, 131072, v98
    v_add_u32 v103, 131072, v101
    s_lshl_b32 s44, s37, 15
    s_lshl_b32 s39, s21, 12
    s_add_u32 s44, s44, s39
    s_lshl_b32 s39, s36, 11
    s_add_u32 s44, s44, s39
    s_add_u32 s44, s44, s16
    s_add_u32 s45, s44, 44040192
    s_add_u32 s44, s44, 8388608
    v_mov_b32 v8, 0
    v_mov_b32 v9, 0
    v_mov_b32 v10, 0
    v_mov_b32 v11, 0
    v_mov_b32 v12, 0
    v_mov_b32 v13, 0
    v_mov_b32 v14, 0
    v_mov_b32 v15, 0
    v_mov_b32 v16, 0
    v_mov_b32 v17, 0
    v_mov_b32 v18, 0
    v_mov_b32 v19, 0
    v_mov_b32 v20, 0
    v_mov_b32 v21, 0
    v_mov_b32 v22, 0
    v_mov_b32 v23, 0
    v_mov_b32 v97, 0x3f803f80
    s_barrier
    buffer_load_dwordx4 v[88:91], v1, s[12:15], s44 offen sc1
    buffer_load_dwordx4 v[92:95], v1, s[12:15], s44 offen offset:1024 sc1
    ds_read_b128 v[24:27], v98 offset:0
    ds_read_b128 v[28:31], v102 offset:0
    ds_read_b128 v[32:35], v98 offset:1024
    ds_read_b128 v[36:39], v102 offset:2048
    ds_read_b128 v[40:43], v98 offset:2048
    ds_read_b128 v[44:47], v102 offset:4096
    ds_read_b128 v[48:51], v98 offset:3072
    ds_read_b128 v[52:55], v102 offset:6144
    ds_read_b128 v[56:59], v98 offset:4096
    ds_read_b128 v[60:63], v102 offset:8192
    ds_read_b128 v[64:67], v98 offset:5120
    ds_read_b128 v[68:71], v102 offset:10240
    ds_read_b128 v[72:75], v98 offset:6144
    ds_read_b128 v[76:79], v102 offset:12288
    s_waitcnt lgkmcnt(12)
    v_mfma_f32_32x32x16_bf16 v[8:23], v[28:31], v[24:27], v[8:23]
    ds_read_b128 v[80:83], v98 offset:7168
    ds_read_b128 v[84:87], v102 offset:14336
    s_waitcnt lgkmcnt(12)
    v_mfma_f32_32x32x16_bf16 v[8:23], v[36:39], v[32:35], v[8:23]
    s_barrier
    ds_read_b128 v[24:27], v98 offset:16384
    ds_read_b128 v[28:31], v102 offset:16384
    s_waitcnt lgkmcnt(12)
    v_mfma_f32_32x32x16_bf16 v[8:23], v[44:47], v[40:43], v[8:23]
    ds_read_b128 v[32:35], v98 offset:17408
    ds_read_b128 v[36:39], v102 offset:18432
    s_waitcnt lgkmcnt(12)
    v_mfma_f32_32x32x16_bf16 v[8:23], v[52:55], v[48:51], v[8:23]
    ds_read_b128 v[40:43], v98 offset:18432
    ds_read_b128 v[44:47], v102 offset:20480
    s_waitcnt lgkmcnt(12)
    v_mfma_f32_32x32x16_bf16 v[8:23], v[60:63], v[56:59], v[8:23]
    ds_read_b128 v[48:51], v98 offset:19456
    ds_read_b128 v[52:55], v102 offset:22528
    s_waitcnt lgkmcnt(12)
    v_mfma_f32_32x32x16_bf16 v[8:23], v[68:71], v[64:67], v[8:23]
    ds_read_b128 v[56:59], v98 offset:20480
    ds_read_b128 v[60:63], v102 offset:24576
    s_waitcnt lgkmcnt(12)
    v_mfma_f32_32x32x16_bf16 v[8:23], v[76:79], v[72:75], v[8:23]
    ds_read_b128 v[64:67], v98 offset:21504
    ds_read_b128 v[68:71], v102 offset:26624
    s_waitcnt lgkmcnt(12)
    v_mfma_f32_32x32x16_bf16 v[8:23], v[84:87], v[80:83], v[8:23]
    ds_read_b128 v[72:75], v98 offset:22528
    ds_read_b128 v[76:79], v102 offset:28672
    s_waitcnt lgkmcnt(12)
    v_mfma_f32_32x32x16_bf16 v[8:23], v[28:31], v[24:27], v[8:23]
    ds_read_b128 v[80:83], v98 offset:23552
    ds_read_b128 v[84:87], v102 offset:30720
    s_waitcnt lgkmcnt(12)
    v_mfma_f32_32x32x16_bf16 v[8:23], v[36:39], v[32:35], v[8:23]
    s_barrier
    ds_read_b128 v[24:27], v98 offset:32768
    ds_read_b128 v[28:31], v102 offset:32768
    s_waitcnt lgkmcnt(12)
    v_mfma_f32_32x32x16_bf16 v[8:23], v[44:47], v[40:43], v[8:23]
    ds_read_b128 v[32:35], v98 offset:33792
    ds_read_b128 v[36:39], v102 offset:34816
    s_waitcnt lgkmcnt(12)
    v_mfma_f32_32x32x16_bf16 v[8:23], v[52:55], v[48:51], v[8:23]
    ds_read_b128 v[40:43], v98 offset:34816
    ds_read_b128 v[44:47], v102 offset:36864
    s_waitcnt lgkmcnt(12)
    v_mfma_f32_32x32x16_bf16 v[8:23], v[60:63], v[56:59], v[8:23]
    ds_read_b128 v[48:51], v98 offset:35840
    ds_read_b128 v[52:55], v102 offset:38912
    s_waitcnt lgkmcnt(12)
    v_mfma_f32_32x32x16_bf16 v[8:23], v[68:71], v[64:67], v[8:23]
    ds_read_b128 v[56:59], v98 offset:36864
    ds_read_b128 v[60:63], v102 offset:40960
    s_waitcnt lgkmcnt(12)
    v_mfma_f32_32x32x16_bf16 v[8:23], v[76:79], v[72:75], v[8:23]
    ds_read_b128 v[64:67], v98 offset:37888
    ds_read_b128 v[68:71], v102 offset:43008
    s_waitcnt lgkmcnt(12)
    v_mfma_f32_32x32x16_bf16 v[8:23], v[84:87], v[80:83], v[8:23]
    ds_read_b128 v[72:75], v98 offset:38912
    ds_read_b128 v[76:79], v102 offset:45056
    s_waitcnt lgkmcnt(12)
    v_mfma_f32_32x32x16_bf16 v[8:23], v[28:31], v[24:27], v[8:23]
    ds_read_b128 v[80:83], v98 offset:39936
    ds_read_b128 v[84:87], v102 offset:47104
    s_waitcnt lgkmcnt(12)
    v_mfma_f32_32x32x16_bf16 v[8:23], v[36:39], v[32:35], v[8:23]
    s_barrier
    ds_read_b128 v[24:27], v98 offset:49152
    ds_read_b128 v[28:31], v102 offset:49152
    s_waitcnt lgkmcnt(12)
    v_mfma_f32_32x32x16_bf16 v[8:23], v[44:47], v[40:43], v[8:23]
    ds_read_b128 v[32:35], v98 offset:50176
    ds_read_b128 v[36:39], v102 offset:51200
    s_waitcnt lgkmcnt(12)
    v_mfma_f32_32x32x16_bf16 v[8:23], v[52:55], v[48:51], v[8:23]
    ds_read_b128 v[40:43], v98 offset:51200
    ds_read_b128 v[44:47], v102 offset:53248
    s_waitcnt lgkmcnt(12)
    v_mfma_f32_32x32x16_bf16 v[8:23], v[60:63], v[56:59], v[8:23]
    ds_read_b128 v[48:51], v98 offset:52224
    ds_read_b128 v[52:55], v102 offset:55296
    s_waitcnt lgkmcnt(12)
    v_mfma_f32_32x32x16_bf16 v[8:23], v[68:71], v[64:67], v[8:23]
    ds_read_b128 v[56:59], v98 offset:53248
    ds_read_b128 v[60:63], v102 offset:57344
    s_waitcnt lgkmcnt(12)
    v_mfma_f32_32x32x16_bf16 v[8:23], v[76:79], v[72:75], v[8:23]
    ds_read_b128 v[64:67], v98 offset:54272
    ds_read_b128 v[68:71], v102 offset:59392
    s_waitcnt lgkmcnt(12)
    v_mfma_f32_32x32x16_bf16 v[8:23], v[84:87], v[80:83], v[8:23]
    ds_read_b128 v[72:75], v98 offset:55296
    ds_read_b128 v[76:79], v102 offset:61440
    s_waitcnt lgkmcnt(12)
    v_mfma_f32_32x32x16_bf16 v[8:23], v[28:31], v[24:27], v[8:23]
    ds_read_b128 v[80:83], v98 offset:56320
    ds_read_b128 v[84:87], v102 offset:63488
    s_waitcnt lgkmcnt(12)
    v_mfma_f32_32x32x16_bf16 v[8:23], v[36:39], v[32:35], v[8:23]
    s_barrier
    ds_read_b128 v[24:27], v100 offset:0
    ds_read_b128 v[28:31], v103 offset:16384
    s_waitcnt lgkmcnt(12)
    v_mfma_f32_32x32x16_bf16 v[8:23], v[44:47], v[40:43], v[8:23]
    ds_read_b128 v[32:35], v100 offset:1024
    ds_read_b128 v[36:39], v103 offset:18432
    s_waitcnt lgkmcnt(12)
    v_mfma_f32_32x32x16_bf16 v[8:23], v[52:55], v[48:51], v[8:23]
    ds_read_b128 v[40:43], v100 offset:2048
    ds_read_b128 v[44:47], v103 offset:20480
    s_waitcnt lgkmcnt(12)
    v_mfma_f32_32x32x16_bf16 v[8:23], v[60:63], v[56:59], v[8:23]
    ds_read_b128 v[48:51], v100 offset:3072
    ds_read_b128 v[52:55], v103 offset:22528
    s_waitcnt lgkmcnt(12)
    v_mfma_f32_32x32x16_bf16 v[8:23], v[68:71], v[64:67], v[8:23]
    ds_read_b128 v[56:59], v100 offset:4096
    ds_read_b128 v[60:63], v103 offset:24576
    s_waitcnt lgkmcnt(12)
    v_mfma_f32_32x32x16_bf16 v[8:23], v[76:79], v[72:75], v[8:23]
    ds_read_b128 v[64:67], v100 offset:5120
    ds_read_b128 v[68:71], v103 offset:26624
    s_waitcnt lgkmcnt(12)
    v_mfma_f32_32x32x16_bf16 v[8:23], v[84:87], v[80:83], v[8:23]
    ds_read_b128 v[72:75], v100 offset:6144
    ds_read_b128 v[76:79], v103 offset:28672
    s_waitcnt lgkmcnt(12)
    v_mfma_f32_32x32x16_bf16 v[8:23], v[28:31], v[24:27], v[8:23]
    ds_read_b128 v[80:83], v100 offset:7168
    ds_read_b128 v[84:87], v103 offset:30720
    s_waitcnt lgkmcnt(12)
    v_mfma_f32_32x32x16_bf16 v[8:23], v[36:39], v[32:35], v[8:23]
    s_barrier
    ds_read_b128 v[24:27], v98 offset:0
    ds_read_b128 v[28:31], v102 offset:0
    s_waitcnt lgkmcnt(12)
    v_mfma_f32_32x32x16_bf16 v[8:23], v[44:47], v[40:43], v[8:23]
    ds_read_b128 v[32:35], v98 offset:1024
    ds_read_b128 v[36:39], v102 offset:2048
    s_waitcnt lgkmcnt(12)
    v_mfma_f32_32x32x16_bf16 v[8:23], v[52:55], v[48:51], v[8:23]
    ds_read_b128 v[40:43], v98 offset:2048
    ds_read_b128 v[44:47], v102 offset:4096
    s_waitcnt lgkmcnt(12)
    v_mfma_f32_32x32x16_bf16 v[8:23], v[60:63], v[56:59], v[8:23]
    ds_read_b128 v[48:51], v98 offset:3072
    ds_read_b128 v[52:55], v102 offset:6144
    s_waitcnt lgkmcnt(12)
    v_mfma_f32_32x32x16_bf16 v[8:23], v[68:71], v[64:67], v[8:23]
    ds_read_b128 v[56:59], v98 offset:4096
    ds_read_b128 v[60:63], v102 offset:8192
    s_waitcnt lgkmcnt(12)
    v_mfma_f32_32x32x16_bf16 v[8:23], v[76:79], v[72:75], v[8:23]
    ds_read_b128 v[64:67], v98 offset:5120
    ds_read_b128 v[68:71], v102 offset:10240
    s_waitcnt lgkmcnt(12)
    v_mfma_f32_32x32x16_bf16 v[8:23], v[84:87], v[80:83], v[8:23]
    ds_read_b128 v[72:75], v98 offset:6144
    ds_read_b128 v[76:79], v102 offset:12288
    s_waitcnt lgkmcnt(12)
    v_mfma_f32_32x32x16_bf16 v[8:23], v[28:31], v[24:27], v[8:23]
    ds_read_b128 v[80:83], v98 offset:7168
    ds_read_b128 v[84:87], v102 offset:14336
    s_waitcnt lgkmcnt(12)
    v_mfma_f32_32x32x16_bf16 v[8:23], v[36:39], v[32:35], v[8:23]
    s_barrier
    ds_read_b128 v[24:27], v98 offset:16384
    ds_read_b128 v[28:31], v102 offset:16384
    s_waitcnt lgkmcnt(12)
    v_mfma_f32_32x32x16_bf16 v[8:23], v[44:47], v[40:43], v[8:23]
    ds_read_b128 v[32:35], v98 offset:17408
    ds_read_b128 v[36:39], v102 offset:18432
    s_waitcnt lgkmcnt(12)
    v_mfma_f32_32x32x16_bf16 v[8:23], v[52:55], v[48:51], v[8:23]
    ds_read_b128 v[40:43], v98 offset:18432
    ds_read_b128 v[44:47], v102 offset:20480
    s_waitcnt lgkmcnt(12)
    v_mfma_f32_32x32x16_bf16 v[8:23], v[60:63], v[56:59], v[8:23]
    ds_read_b128 v[48:51], v98 offset:19456
    ds_read_b128 v[52:55], v102 offset:22528
    s_waitcnt lgkmcnt(12)
    v_mfma_f32_32x32x16_bf16 v[8:23], v[68:71], v[64:67], v[8:23]
    ds_read_b128 v[56:59], v98 offset:20480
    ds_read_b128 v[60:63], v102 offset:24576
    s_waitcnt lgkmcnt(12)
    v_mfma_f32_32x32x16_bf16 v[8:23], v[76:79], v[72:75], v[8:23]
    ds_read_b128 v[64:67], v98 offset:21504
    ds_read_b128 v[68:71], v102 offset:26624
    s_waitcnt lgkmcnt(12)
    v_mfma_f32_32x32x16_bf16 v[8:23], v[84:87], v[80:83], v[8:23]
    ds_read_b128 v[72:75], v98 offset:22528
    ds_read_b128 v[76:79], v102 offset:28672
    s_waitcnt lgkmcnt(12)
    v_mfma_f32_32x32x16_bf16 v[8:23], v[28:31], v[24:27], v[8:23]
    ds_read_b128 v[80:83], v98 offset:23552
    ds_read_b128 v[84:87], v102 offset:30720
    s_waitcnt lgkmcnt(12)
    v_mfma_f32_32x32x16_bf16 v[8:23], v[36:39], v[32:35], v[8:23]
    s_barrier
    ds_read_b128 v[24:27], v98 offset:32768
    ds_read_b128 v[28:31], v102 offset:32768
    s_waitcnt lgkmcnt(12)
    v_mfma_f32_32x32x16_bf16 v[8:23], v[44:47], v[40:43], v[8:23]
    ds_read_b128 v[32:35], v98 offset:33792
    ds_read_b128 v[36:39], v102 offset:34816
    s_waitcnt lgkmcnt(12)
    v_mfma_f32_32x32x16_bf16 v[8:23], v[52:55], v[48:51], v[8:23]
    ds_read_b128 v[40:43], v98 offset:34816
    ds_read_b128 v[44:47], v102 offset:36864
    s_waitcnt lgkmcnt(12)
    v_mfma_f32_32x32x16_bf16 v[8:23], v[60:63], v[56:59], v[8:23]
    ds_read_b128 v[48:51], v98 offset:35840
    ds_read_b128 v[52:55], v102 offset:38912
    s_waitcnt lgkmcnt(12)
    v_mfma_f32_32x32x16_bf16 v[8:23], v[68:71], v[64:67], v[8:23]
    ds_read_b128 v[56:59], v98 offset:36864
    ds_read_b128 v[60:63], v102 offset:40960
    s_waitcnt lgkmcnt(12)
    v_mfma_f32_32x32x16_bf16 v[8:23], v[76:79], v[72:75], v[8:23]
    ds_read_b128 v[64:67], v98 offset:37888
    ds_read_b128 v[68:71], v102 offset:43008
    s_waitcnt lgkmcnt(12)
    v_mfma_f32_32x32x16_bf16 v[8:23], v[84:87], v[80:83], v[8:23]
    ds_read_b128 v[72:75], v98 offset:38912
    ds_read_b128 v[76:79], v102 offset:45056
    s_waitcnt lgkmcnt(12)
    v_mfma_f32_32x32x16_bf16 v[8:23], v[28:31], v[24:27], v[8:23]
    ds_read_b128 v[80:83], v98 offset:39936
    ds_read_b128 v[84:87], v102 offset:47104
    s_waitcnt lgkmcnt(12)
    v_mfma_f32_32x32x16_bf16 v[8:23], v[36:39], v[32:35], v[8:23]
    s_barrier
    ds_read_b128 v[24:27], v98 offset:49152
    ds_read_b128 v[28:31], v102 offset:49152
    s_waitcnt lgkmcnt(12)
    v_mfma_f32_32x32x16_bf16 v[8:23], v[44:47], v[40:43], v[8:23]
    ds_read_b128 v[32:35], v98 offset:50176
    ds_read_b128 v[36:39], v102 offset:51200
    s_waitcnt lgkmcnt(12)
    v_mfma_f32_32x32x16_bf16 v[8:23], v[52:55], v[48:51], v[8:23]
    ds_read_b128 v[40:43], v98 offset:51200
    ds_read_b128 v[44:47], v102 offset:53248
    s_waitcnt lgkmcnt(12)
    v_mfma_f32_32x32x16_bf16 v[8:23], v[60:63], v[56:59], v[8:23]
    ds_read_b128 v[48:51], v98 offset:52224
    ds_read_b128 v[52:55], v102 offset:55296
    s_waitcnt lgkmcnt(12)
    v_mfma_f32_32x32x16_bf16 v[8:23], v[68:71], v[64:67], v[8:23]
    ds_read_b128 v[56:59], v98 offset:53248
    ds_read_b128 v[60:63], v102 offset:57344
    s_waitcnt lgkmcnt(12)
    v_mfma_f32_32x32x16_bf16 v[8:23], v[76:79], v[72:75], v[8:23]
    ds_read_b128 v[64:67], v98 offset:54272
    ds_read_b128 v[68:71], v102 offset:59392
    s_waitcnt lgkmcnt(12)
    v_mfma_f32_32x32x16_bf16 v[8:23], v[84:87], v[80:83], v[8:23]
    ds_read_b128 v[72:75], v98 offset:55296
    ds_read_b128 v[76:79], v102 offset:61440
    s_waitcnt lgkmcnt(12)
    v_mfma_f32_32x32x16_bf16 v[8:23], v[28:31], v[24:27], v[8:23]
    ds_read_b128 v[80:83], v98 offset:56320
    ds_read_b128 v[84:87], v102 offset:63488
    s_waitcnt lgkmcnt(12)
    v_mfma_f32_32x32x16_bf16 v[8:23], v[36:39], v[32:35], v[8:23]
    s_barrier
    ds_read_b128 v[24:27], v100 offset:0
    ds_read_b128 v[28:31], v103 offset:16384
    s_waitcnt lgkmcnt(12)
    v_mfma_f32_32x32x16_bf16 v[8:23], v[44:47], v[40:43], v[8:23]
    ds_read_b128 v[32:35], v100 offset:1024
    ds_read_b128 v[36:39], v103 offset:18432
    s_waitcnt lgkmcnt(12)
    v_mfma_f32_32x32x16_bf16 v[8:23], v[52:55], v[48:51], v[8:23]
    ds_read_b128 v[40:43], v100 offset:2048
    ds_read_b128 v[44:47], v103 offset:20480
    s_waitcnt lgkmcnt(12)
    v_mfma_f32_32x32x16_bf16 v[8:23], v[60:63], v[56:59], v[8:23]
    ds_read_b128 v[48:51], v100 offset:3072
    ds_read_b128 v[52:55], v103 offset:22528
    s_waitcnt lgkmcnt(12)
    v_mfma_f32_32x32x16_bf16 v[8:23], v[68:71], v[64:67], v[8:23]
    ds_read_b128 v[56:59], v100 offset:4096
    ds_read_b128 v[60:63], v103 offset:24576
    s_waitcnt lgkmcnt(12)
    v_mfma_f32_32x32x16_bf16 v[8:23], v[76:79], v[72:75], v[8:23]
    ds_read_b128 v[64:67], v100 offset:5120
    ds_read_b128 v[68:71], v103 offset:26624
    s_waitcnt lgkmcnt(12)
    v_mfma_f32_32x32x16_bf16 v[8:23], v[84:87], v[80:83], v[8:23]
    ds_read_b128 v[72:75], v100 offset:6144
    ds_read_b128 v[76:79], v103 offset:28672
    s_waitcnt lgkmcnt(12)
    v_mfma_f32_32x32x16_bf16 v[8:23], v[28:31], v[24:27], v[8:23]
    ds_read_b128 v[80:83], v100 offset:7168
    ds_read_b128 v[84:87], v103 offset:30720
    s_waitcnt lgkmcnt(12)
    v_mfma_f32_32x32x16_bf16 v[8:23], v[36:39], v[32:35], v[8:23]
    s_barrier
    ds_read_b128 v[24:27], v98 offset:0
    ds_read_b128 v[28:31], v102 offset:0
    s_waitcnt lgkmcnt(12)
    v_mfma_f32_32x32x16_bf16 v[8:23], v[44:47], v[40:43], v[8:23]
    ds_read_b128 v[32:35], v98 offset:1024
    ds_read_b128 v[36:39], v102 offset:2048
    s_waitcnt lgkmcnt(12)
    v_mfma_f32_32x32x16_bf16 v[8:23], v[52:55], v[48:51], v[8:23]
    ds_read_b128 v[40:43], v98 offset:2048
    ds_read_b128 v[44:47], v102 offset:4096
    s_waitcnt lgkmcnt(12)
    v_mfma_f32_32x32x16_bf16 v[8:23], v[60:63], v[56:59], v[8:23]
    ds_read_b128 v[48:51], v98 offset:3072
    ds_read_b128 v[52:55], v102 offset:6144
    s_waitcnt lgkmcnt(12)
    v_mfma_f32_32x32x16_bf16 v[8:23], v[68:71], v[64:67], v[8:23]
    ds_read_b128 v[56:59], v98 offset:4096
    ds_read_b128 v[60:63], v102 offset:8192
    s_waitcnt lgkmcnt(12)
    v_mfma_f32_32x32x16_bf16 v[8:23], v[76:79], v[72:75], v[8:23]
    ds_read_b128 v[64:67], v98 offset:5120
    ds_read_b128 v[68:71], v102 offset:10240
    s_waitcnt lgkmcnt(12)
    v_mfma_f32_32x32x16_bf16 v[8:23], v[84:87], v[80:83], v[8:23]
    ds_read_b128 v[72:75], v98 offset:6144
    ds_read_b128 v[76:79], v102 offset:12288
    s_waitcnt lgkmcnt(12)
    v_mfma_f32_32x32x16_bf16 v[8:23], v[28:31], v[24:27], v[8:23]
    ds_read_b128 v[80:83], v98 offset:7168
    ds_read_b128 v[84:87], v102 offset:14336
    s_waitcnt lgkmcnt(12)
    v_mfma_f32_32x32x16_bf16 v[8:23], v[36:39], v[32:35], v[8:23]
    s_barrier
    ds_read_b128 v[24:27], v98 offset:16384
    ds_read_b128 v[28:31], v102 offset:16384
    s_waitcnt lgkmcnt(12)
    v_mfma_f32_32x32x16_bf16 v[8:23], v[44:47], v[40:43], v[8:23]
    ds_read_b128 v[32:35], v98 offset:17408
    ds_read_b128 v[36:39], v102 offset:18432
    s_waitcnt lgkmcnt(12)
    v_mfma_f32_32x32x16_bf16 v[8:23], v[52:55], v[48:51], v[8:23]
    ds_read_b128 v[40:43], v98 offset:18432
    ds_read_b128 v[44:47], v102 offset:20480
    s_waitcnt lgkmcnt(12)
    v_mfma_f32_32x32x16_bf16 v[8:23], v[60:63], v[56:59], v[8:23]
    ds_read_b128 v[48:51], v98 offset:19456
    ds_read_b128 v[52:55], v102 offset:22528
    s_waitcnt lgkmcnt(12)
    v_mfma_f32_32x32x16_bf16 v[8:23], v[68:71], v[64:67], v[8:23]
    ds_read_b128 v[56:59], v98 offset:20480
    ds_read_b128 v[60:63], v102 offset:24576
    s_waitcnt lgkmcnt(12)
    v_mfma_f32_32x32x16_bf16 v[8:23], v[76:79], v[72:75], v[8:23]
    ds_read_b128 v[64:67], v98 offset:21504
    ds_read_b128 v[68:71], v102 offset:26624
    s_waitcnt lgkmcnt(12)
    v_mfma_f32_32x32x16_bf16 v[8:23], v[84:87], v[80:83], v[8:23]
    ds_read_b128 v[72:75], v98 offset:22528
    ds_read_b128 v[76:79], v102 offset:28672
    s_waitcnt lgkmcnt(12)
    v_mfma_f32_32x32x16_bf16 v[8:23], v[28:31], v[24:27], v[8:23]
    ds_read_b128 v[80:83], v98 offset:23552
    ds_read_b128 v[84:87], v102 offset:30720
    s_waitcnt lgkmcnt(12)
    v_mfma_f32_32x32x16_bf16 v[8:23], v[36:39], v[32:35], v[8:23]
    s_barrier
    ds_read_b128 v[24:27], v98 offset:32768
    ds_read_b128 v[28:31], v102 offset:32768
    s_waitcnt lgkmcnt(12)
    v_mfma_f32_32x32x16_bf16 v[8:23], v[44:47], v[40:43], v[8:23]
    ds_read_b128 v[32:35], v98 offset:33792
    ds_read_b128 v[36:39], v102 offset:34816
    s_waitcnt lgkmcnt(12)
    v_mfma_f32_32x32x16_bf16 v[8:23], v[52:55], v[48:51], v[8:23]
    ds_read_b128 v[40:43], v98 offset:34816
    ds_read_b128 v[44:47], v102 offset:36864
    s_waitcnt lgkmcnt(12)
    v_mfma_f32_32x32x16_bf16 v[8:23], v[60:63], v[56:59], v[8:23]
    ds_read_b128 v[48:51], v98 offset:35840
    ds_read_b128 v[52:55], v102 offset:38912
    s_waitcnt lgkmcnt(12)
    v_mfma_f32_32x32x16_bf16 v[8:23], v[68:71], v[64:67], v[8:23]
    ds_read_b128 v[56:59], v98 offset:36864
    ds_read_b128 v[60:63], v102 offset:40960
    s_waitcnt lgkmcnt(12)
    v_mfma_f32_32x32x16_bf16 v[8:23], v[76:79], v[72:75], v[8:23]
    ds_read_b128 v[64:67], v98 offset:37888
    ds_read_b128 v[68:71], v102 offset:43008
    s_waitcnt lgkmcnt(12)
    v_mfma_f32_32x32x16_bf16 v[8:23], v[84:87], v[80:83], v[8:23]
    ds_read_b128 v[72:75], v98 offset:38912
    ds_read_b128 v[76:79], v102 offset:45056
    s_waitcnt lgkmcnt(12)
    v_mfma_f32_32x32x16_bf16 v[8:23], v[28:31], v[24:27], v[8:23]
    ds_read_b128 v[80:83], v98 offset:39936
    ds_read_b128 v[84:87], v102 offset:47104
    s_waitcnt lgkmcnt(12)
    v_mfma_f32_32x32x16_bf16 v[8:23], v[36:39], v[32:35], v[8:23]
    s_barrier
    ds_read_b128 v[24:27], v98 offset:49152
    ds_read_b128 v[28:31], v102 offset:49152
    s_waitcnt lgkmcnt(12)
    v_mfma_f32_32x32x16_bf16 v[8:23], v[44:47], v[40:43], v[8:23]
    ds_read_b128 v[32:35], v98 offset:50176
    ds_read_b128 v[36:39], v102 offset:51200
    s_waitcnt lgkmcnt(12)
    v_mfma_f32_32x32x16_bf16 v[8:23], v[52:55], v[48:51], v[8:23]
    ds_read_b128 v[40:43], v98 offset:51200
    ds_read_b128 v[44:47], v102 offset:53248
    s_waitcnt lgkmcnt(12)
    v_mfma_f32_32x32x16_bf16 v[8:23], v[60:63], v[56:59], v[8:23]
    ds_read_b128 v[48:51], v98 offset:52224
    ds_read_b128 v[52:55], v102 offset:55296
    s_waitcnt lgkmcnt(12)
    v_mfma_f32_32x32x16_bf16 v[8:23], v[68:71], v[64:67], v[8:23]
    ds_read_b128 v[56:59], v98 offset:53248
    ds_read_b128 v[60:63], v102 offset:57344
    s_waitcnt lgkmcnt(12)
    v_mfma_f32_32x32x16_bf16 v[8:23], v[76:79], v[72:75], v[8:23]
    ds_read_b128 v[64:67], v98 offset:54272
    ds_read_b128 v[68:71], v102 offset:59392
    s_waitcnt lgkmcnt(12)
    v_mfma_f32_32x32x16_bf16 v[8:23], v[84:87], v[80:83], v[8:23]
    ds_read_b128 v[72:75], v98 offset:55296
    ds_read_b128 v[76:79], v102 offset:61440
    s_waitcnt lgkmcnt(12)
    v_mfma_f32_32x32x16_bf16 v[8:23], v[28:31], v[24:27], v[8:23]
    ds_read_b128 v[80:83], v98 offset:56320
    ds_read_b128 v[84:87], v102 offset:63488
    s_waitcnt lgkmcnt(12)
    v_mfma_f32_32x32x16_bf16 v[8:23], v[36:39], v[32:35], v[8:23]
    s_waitcnt lgkmcnt(10)
    v_mfma_f32_32x32x16_bf16 v[8:23], v[44:47], v[40:43], v[8:23]
    s_waitcnt lgkmcnt(8)
    v_mfma_f32_32x32x16_bf16 v[8:23], v[52:55], v[48:51], v[8:23]
    s_waitcnt lgkmcnt(6)
    v_mfma_f32_32x32x16_bf16 v[8:23], v[60:63], v[56:59], v[8:23]
    s_waitcnt lgkmcnt(4)
    v_mfma_f32_32x32x16_bf16 v[8:23], v[68:71], v[64:67], v[8:23]
    s_waitcnt lgkmcnt(2)
    v_mfma_f32_32x32x16_bf16 v[8:23], v[76:79], v[72:75], v[8:23]
    s_waitcnt lgkmcnt(0)
    v_mfma_f32_32x32x16_bf16 v[8:23], v[84:87], v[80:83], v[8:23]
    s_nop 11
    v_cvt_pk_bf16_f32 v104, v8, v9
    v_cvt_pk_bf16_f32 v105, v10, v11
    v_cvt_pk_bf16_f32 v106, v12, v13
    v_cvt_pk_bf16_f32 v107, v14, v15
    v_cvt_pk_bf16_f32 v108, v16, v17
    v_cvt_pk_bf16_f32 v109, v18, v19
    v_cvt_pk_bf16_f32 v110, v20, v21
    v_cvt_pk_bf16_f32 v111, v22, v23
    v_permlane32_swap_b32 v104, v106
    v_permlane32_swap_b32 v105, v107
    v_permlane32_swap_b32 v108, v110
    v_permlane32_swap_b32 v109, v111
    s_waitcnt vmcnt(0)
    v_lshlrev_b32 v112, 16, v104
    v_and_b32 v113, 0xffff0000, v104
    v_lshlrev_b32 v128, 16, v88
    v_and_b32 v129, 0xffff0000, v88
    v_lshlrev_b32 v114, 16, v105
    v_and_b32 v115, 0xffff0000, v105
    v_lshlrev_b32 v130, 16, v89
    v_and_b32 v131, 0xffff0000, v89
    v_lshlrev_b32 v116, 16, v106
    v_and_b32 v117, 0xffff0000, v106
    v_lshlrev_b32 v132, 16, v90
    v_and_b32 v133, 0xffff0000, v90
    v_lshlrev_b32 v118, 16, v107
    v_and_b32 v119, 0xffff0000, v107
    v_lshlrev_b32 v134, 16, v91
    v_and_b32 v135, 0xffff0000, v91
    v_lshlrev_b32 v120, 16, v108
    v_and_b32 v121, 0xffff0000, v108
    v_lshlrev_b32 v136, 16, v92
    v_and_b32 v137, 0xffff0000, v92
    v_lshlrev_b32 v122, 16, v109
    v_and_b32 v123, 0xffff0000, v109
    v_lshlrev_b32 v138, 16, v93
    v_and_b32 v139, 0xffff0000, v93
    v_lshlrev_b32 v124, 16, v110
    v_and_b32 v125, 0xffff0000, v110
    v_lshlrev_b32 v140, 16, v94
    v_and_b32 v141, 0xffff0000, v94
    v_lshlrev_b32 v126, 16, v111
    v_and_b32 v127, 0xffff0000, v111
    v_lshlrev_b32 v142, 16, v95
    v_and_b32 v143, 0xffff0000, v95
    v_add_f32 v112, v112, v128
    v_add_f32 v113, v113, v129
    v_add_f32 v114, v114, v130
    v_add_f32 v115, v115, v131
    v_add_f32 v116, v116, v132
    v_add_f32 v117, v117, v133
    v_add_f32 v118, v118, v134
    v_add_f32 v119, v119, v135
    v_add_f32 v120, v120, v136
    v_add_f32 v121, v121, v137
    v_add_f32 v122, v122, v138
    v_add_f32 v123, v123, v139
    v_add_f32 v124, v124, v140
    v_add_f32 v125, v125, v141
    v_add_f32 v126, v126, v142
    v_add_f32 v127, v127, v143
    v_cvt_pk_bf16_f32 v104, v112, v113
    v_cvt_pk_bf16_f32 v105, v114, v115
    v_cvt_pk_bf16_f32 v106, v116, v117
    v_cvt_pk_bf16_f32 v107, v118, v119
    v_cvt_pk_bf16_f32 v108, v120, v121
    v_cvt_pk_bf16_f32 v109, v122, v123
    v_cvt_pk_bf16_f32 v110, v124, v125
    v_cvt_pk_bf16_f32 v111, v126, v127
    s_cmp_lg_u32 s18, 0
    s_cbranch_scc1 mega_kernel_p5fin78
    buffer_store_dwordx4 v[104:107], v1, s[12:15], s45 offen sc1
    buffer_store_dwordx4 v[108:111], v1, s[12:15], s45 offen offset:1024 sc1
    v_mov_b32 v112, 0
    v_mov_b32 v113, 0
    v_dot2_f32_bf16 v112, v104, v97, v112
    v_dot2_f32_bf16 v113, v104, v104, v113
    v_dot2_f32_bf16 v112, v105, v97, v112
    v_dot2_f32_bf16 v113, v105, v105, v113
    v_dot2_f32_bf16 v112, v106, v97, v112
    v_dot2_f32_bf16 v113, v106, v106, v113
    v_dot2_f32_bf16 v112, v107, v97, v112
    v_dot2_f32_bf16 v113, v107, v107, v113
    v_dot2_f32_bf16 v112, v108, v97, v112
    v_dot2_f32_bf16 v113, v108, v108, v113
    v_dot2_f32_bf16 v112, v109, v97, v112
    v_dot2_f32_bf16 v113, v109, v109, v113
    v_dot2_f32_bf16 v112, v110, v97, v112
    v_dot2_f32_bf16 v113, v110, v110, v113
    v_dot2_f32_bf16 v112, v111, v97, v112
    v_dot2_f32_bf16 v113, v111, v111, v113
    s_nop 1
    v_mov_b32 v114, v112
    v_mov_b32 v115, v113
    s_nop 0
    v_permlane32_swap_b32 v114, v112
    v_permlane32_swap_b32 v115, v113
    v_add_f32 v112, v112, v114
    v_add_f32 v113, v113, v115
    v_and_b32 v2, 31, v0
    v_lshlrev_b32 v2, 4, v2
    s_lshl_b32 s46, s37, 12
    s_lshl_b32 s47, s21, 9
    s_add_u32 s46, s46, s47
    s_lshl_b32 s47, s36, 3
    s_add_u32 s46, s46, s47
    s_add_u32 s46, s46, s16
    s_add_u32 s46, s46, 46137344
    buffer_store_dwordx2 v[112:113], v2, s[12:15], s46 offen sc1
    s_branch mega_kernel_p5join79
mega_kernel_p5fin78:
    v_and_b32 v2, 31, v0
    v_lshrrev_b32 v3, 5, v0
    v_lshlrev_b32 v2, 10, v2
    v_lshl_add_u32 v96, v3, 4, v2
    s_lshl_b32 s45, s37, 15
    s_lshl_b32 s39, s21, 7
    s_add_u32 s45, s45, s39
    s_lshl_b32 s39, s36, 6
    s_add_u32 s45, s45, s39
    buffer_store_dwordx4 v[104:107], v96, s[24:27], s45 offen
    buffer_store_dwordx4 v[108:111], v96, s[24:27], s45 offen offset:32
    s_endpgm
mega_kernel_p5join79:
    s_lshl_b32 s40, s20, 3
    v_add_u32 v2, s40, v0
    s_movk_i32 s41, 0x100
    v_cmp_gt_u32 s[42:43], s41, v2
    v_lshlrev_b32 v2, 7, v2
    v_mov_b32 v3, 1
    s_add_u32 s40, s17, 327680
    s_and_b32 s42, s42, 0xff
    s_mov_b32 s43, 0
    s_waitcnt vmcnt(0)
    s_barrier
    s_cmp_lg_u32 s19, 0
    s_cbranch_scc1 mega_kernel_sg80
    s_mov_b64 exec, s[42:43]
    buffer_atomic_add v3, v2, s[12:15], s40 offen sc1
    s_mov_b64 exec, -1
mega_kernel_sg80:
    s_branch mega_kernel_p3end77
mega_kernel_p3idle76:
    s_barrier
    s_barrier
    s_barrier
    s_barrier
    s_barrier
    s_barrier
    s_barrier
    s_barrier
    s_barrier
    s_barrier
    s_barrier
    s_barrier
    s_barrier
    s_barrier
    s_barrier
mega_kernel_p3end77:
    s_add_u32 s18, s18, 1
    s_add_u32 s16, s16, 25165824
    s_add_u32 s17, s17, 196608
    s_cmp_lt_u32 s18, 2
    s_cbranch_scc1 mega_kernel_ctop
    s_endpgm
mega_kernel_loader:
    s_and_b32 s19, s19, 3
    s_mov_b32 s80, s78
    s_and_b32 s81, s79, 0xffff
    s_mov_b32 s82, 256
    s_mov_b32 s83, 0x00020000
    s_sub_u32 s40, s2, 64
    s_cmp_ge_u32 s40, 16
    s_cbranch_scc1 mega_kernel_p0nz6
    s_add_u32 s41, s40, 6
    s_cmp_lt_u32 s40, 12
    s_cselect_b32 s41, s40, s41
    s_lshl_b32 s41, s41, 15
    s_lshl_b32 s42, s19, 13
    s_add_u32 s41, s41, s42
    s_add_u32 s41, s41, 60817408
    s_add_u32 s42, s41, 4096
    v_mov_b32 v4, 0
    v_mov_b32 v5, 0
    v_mov_b32 v6, 0
    v_mov_b32 v7, 0
    buffer_store_dwordx4 v[4:7], v1, s[12:15], s41 offen offset:0 sc1
    buffer_store_dwordx4 v[4:7], v1, s[12:15], s41 offen offset:1024 sc1
    buffer_store_dwordx4 v[4:7], v1, s[12:15], s41 offen offset:2048 sc1
    buffer_store_dwordx4 v[4:7], v1, s[12:15], s41 offen offset:3072 sc1
    buffer_store_dwordx4 v[4:7], v1, s[12:15], s42 offen offset:0 sc1
    buffer_store_dwordx4 v[4:7], v1, s[12:15], s42 offen offset:1024 sc1
    buffer_store_dwordx4 v[4:7], v1, s[12:15], s42 offen offset:2048 sc1
    buffer_store_dwordx4 v[4:7], v1, s[12:15], s42 offen offset:3072 sc1
    s_waitcnt vmcnt(0)
mega_kernel_p0nz6:
    s_mov_b32 s30, s19
    v_lshlrev_b32 v8, 4, v0
    v_mov_b32 v9, 0x3f803f80
    v_lshrrev_b32 v2, 3, v0
    v_and_b32 v3, 7, v0
    v_lshrrev_b32 v4, 5, v0
    v_bfe_u32 v5, v0, 2, 2
    v_bfe_u32 v6, v0, 4, 1
    v_and_b32 v7, 3, v0
    s_cmp_lt_u32 s2, 48
    s_cbranch_scc1 mega_kernel_p0_qkv
    s_cmp_lt_u32 s2, 64
    s_cbranch_scc1 mega_kernel_p0_wo
    s_barrier
    v_mov_b32 v2, 0x100
    s_mov_b32 s57, 589824
    s_branch mega_kernel_p0ab2
mega_kernel_p0_qkv:
    s_mov_b32 s24, s68
    s_and_b32 s25, s69, 0xffff
    s_mov_b32 s26, 1572864
    s_mov_b32 s27, 0x00020000
    s_sub_u32 s31, s2, 0
    s_and_b32 s32, s31, 1
    s_lshr_b32 s33, s31, 1
    v_mul_u32_u24 v10, 3072, v2
    v_lshl_add_u32 v10, v3, 4, v10
    s_mul_i32 s34, s32, 786432
    s_mul_i32 s35, s30, 196608
    s_add_u32 s34, s34, s35
    s_lshl_b32 s35, s33, 7
    s_add_u32 s34, s34, s35
    s_lshl_b32 s36, s30, 13
    s_add_u32 s36, s36, 65536
    s_add_u32 m0, s36, 0
    s_add_u32 s37, s34, 0
    buffer_load_dwordx4 v10, s[24:27], s37 offen lds
    s_add_u32 m0, s36, 1024
    s_add_u32 s37, s34, 24576
    buffer_load_dwordx4 v10, s[24:27], s37 offen lds
    s_add_u32 m0, s36, 2048
    s_add_u32 s37, s34, 49152
    buffer_load_dwordx4 v10, s[24:27], s37 offen lds
    s_add_u32 m0, s36, 3072
    s_add_u32 s37, s34, 73728
    buffer_load_dwordx4 v10, s[24:27], s37 offen lds
    s_add_u32 m0, s36, 4096
    s_add_u32 s37, s34, 98304
    buffer_load_dwordx4 v10, s[24:27], s37 offen lds
    s_add_u32 m0, s36, 5120
    s_add_u32 s37, s34, 122880
    buffer_load_dwordx4 v10, s[24:27], s37 offen lds
    s_add_u32 m0, s36, 6144
    s_add_u32 s37, s34, 147456
    buffer_load_dwordx4 v10, s[24:27], s37 offen lds
    s_add_u32 m0, s36, 7168
    s_add_u32 s37, s34, 172032
    buffer_load_dwordx4 v10, s[24:27], s37 offen lds
    v_lshl_add_u32 v11, v4, 3, v5
    v_lshlrev_b32 v11, 7, v11
    v_lshl_add_u32 v11, v6, 5, v11
    v_lshl_add_u32 v11, v7, 3, v11
    v_add_u32 v11, s36, v11
    s_and_b32 s38, s33, 7
    s_mul_i32 s38, s38, 196608
    s_lshr_b32 s39, s33, 3
    s_lshl_b32 s48, s32, 2
    s_add_u32 s48, s48, s30
    s_lshl_b32 s49, s48, 13
    s_add_u32 s49, s49, 131072
    s_lshl_b32 s50, s48, 14
    s_lshl_b32 s51, s39, 13
    s_add_u32 s50, s50, s51
    s_sub_u32 s50, s50, 8192
    s_cmp_eq_u32 s39, 0
    s_cselect_b32 s49, s49, s50
    s_add_u32 s38, s38, s49
    s_add_u32 s38, s38, 50331648
    s_waitcnt vmcnt(0)
    ds_read_b64_tr_b16 v[16:17], v11 offset:0
    ds_read_b64_tr_b16 v[18:19], v11 offset:512
    ds_read_b64_tr_b16 v[20:21], v11 offset:64
    ds_read_b64_tr_b16 v[22:23], v11 offset:576
    ds_read_b64_tr_b16 v[24:25], v11 offset:2048
    ds_read_b64_tr_b16 v[26:27], v11 offset:2560
    ds_read_b64_tr_b16 v[28:29], v11 offset:2112
    ds_read_b64_tr_b16 v[30:31], v11 offset:2624
    ds_read_b64_tr_b16 v[32:33], v11 offset:4096
    ds_read_b64_tr_b16 v[34:35], v11 offset:4608
    ds_read_b64_tr_b16 v[36:37], v11 offset:4160
    ds_read_b64_tr_b16 v[38:39], v11 offset:4672
    ds_read_b64_tr_b16 v[40:41], v11 offset:6144
    ds_read_b64_tr_b16 v[42:43], v11 offset:6656
    ds_read_b64_tr_b16 v[44:45], v11 offset:6208
    ds_read_b64_tr_b16 v[46:47], v11 offset:6720
    s_waitcnt lgkmcnt(0)
    s_add_u32 s39, s38, 0
    buffer_store_dwordx4 v[16:19], v8, s[12:15], s39 offen offset:0 sc1
    buffer_store_dwordx4 v[20:23], v8, s[12:15], s39 offen offset:1024 sc1
    s_nop 1
    s_add_u32 s39, s38, 2048
    buffer_store_dwordx4 v[24:27], v8, s[12:15], s39 offen offset:0 sc1
    buffer_store_dwordx4 v[28:31], v8, s[12:15], s39 offen offset:1024 sc1
    s_nop 1
    s_add_u32 s39, s38, 4096
    buffer_store_dwordx4 v[32:35], v8, s[12:15], s39 offen offset:0 sc1
    buffer_store_dwordx4 v[36:39], v8, s[12:15], s39 offen offset:1024 sc1
    s_nop 1
    s_add_u32 s39, s38, 6144
    buffer_store_dwordx4 v[40:43], v8, s[12:15], s39 offen offset:0 sc1
    buffer_store_dwordx4 v[44:47], v8, s[12:15], s39 offen offset:1024 sc1
    v_mov_b32 v12, 0
    v_mov_b32 v13, 0
    v_dot2_f32_bf16 v12, v16, v9, v12
    v_dot2_f32_bf16 v13, v20, v9, v13
    v_dot2_f32_bf16 v12, v17, v9, v12
    v_dot2_f32_bf16 v13, v21, v9, v13
    v_dot2_f32_bf16 v12, v18, v9, v12
    v_dot2_f32_bf16 v13, v22, v9, v13
    v_dot2_f32_bf16 v12, v19, v9, v12
    v_dot2_f32_bf16 v13, v23, v9, v13
    v_dot2_f32_bf16 v12, v24, v9, v12
    v_dot2_f32_bf16 v13, v28, v9, v13
    v_dot2_f32_bf16 v12, v25, v9, v12
    v_dot2_f32_bf16 v13, v29, v9, v13
    v_dot2_f32_bf16 v12, v26, v9, v12
    v_dot2_f32_bf16 v13, v30, v9, v13
    v_dot2_f32_bf16 v12, v27, v9, v12
    v_dot2_f32_bf16 v13, v31, v9, v13
    v_dot2_f32_bf16 v12, v32, v9, v12
    v_dot2_f32_bf16 v13, v36, v9, v13
    v_dot2_f32_bf16 v12, v33, v9, v12
    v_dot2_f32_bf16 v13, v37, v9, v13
    v_dot2_f32_bf16 v12, v34, v9, v12
    v_dot2_f32_bf16 v13, v38, v9, v13
    v_dot2_f32_bf16 v12, v35, v9, v12
    v_dot2_f32_bf16 v13, v39, v9, v13
    v_dot2_f32_bf16 v12, v40, v9, v12
    v_dot2_f32_bf16 v13, v44, v9, v13
    v_dot2_f32_bf16 v12, v41, v9, v12
    v_dot2_f32_bf16 v13, v45, v9, v13
    v_dot2_f32_bf16 v12, v42, v9, v12
    v_dot2_f32_bf16 v13, v46, v9, v13
    v_dot2_f32_bf16 v12, v43, v9, v12
    v_dot2_f32_bf16 v13, v47, v9, v13
    s_nop 1
    v_mov_b32 v14, v12
    s_nop 1
    v_permlane32_swap_b32 v14, v12
    v_add_f32 v12, v12, v14
    v_mov_b32 v14, v13
    s_nop 1
    v_permlane32_swap_b32 v14, v13
    v_add_f32 v13, v13, v14
    v_cmp_gt_u32 s[46:47], 32, v0
    s_nop 1
    v_cndmask_b32 v12, v13, v12, s[46:47]
    s_lshl_b32 s39, s30, 8
    s_add_u32 s39, s39, 65536
    v_lshlrev_b32 v14, 2, v0
    v_add_u32 v15, s39, v14
    v_add_u32 v14, 65536, v14
    ds_write_b32 v15, v12 offset:32768
    s_waitcnt lgkmcnt(0)
    s_barrier
    s_cmp_lg_u32 s30, 0
    s_cbranch_scc1 mega_kernel_p0_qkv_fin
    ds_read_b32 v48, v14 offset:32768
    ds_read_b32 v49, v14 offset:33024
    ds_read_b32 v50, v14 offset:33280
    ds_read_b32 v51, v14 offset:33536
    s_waitcnt lgkmcnt(0)
    v_add_f32 v48, v48, v49
    v_add_f32 v50, v50, v51
    v_add_f32 v48, v48, v50
    v_lshrrev_b32 v52, 16, v48
    v_and_b32 v53, 0xffff0000, v48
    v_sub_f32 v53, v48, v53
    v_and_b32 v54, 0xffff0000, v53
    v_or_b32 v52, v52, v54
    v_sub_f32 v53, v53, v54
    v_lshrrev_b32 v53, 16, v53
    v_mov_b32 v54, 0
    v_mov_b32 v55, 0
    v_and_b32 v14, 31, v0
    v_lshlrev_b32 v14, 4, v14
    v_lshl_add_u32 v14, v4, 10, v14
    s_and_b32 s38, s33, 7
    s_lshl_b32 s38, s38, 13
    s_lshr_b32 s39, s33, 3
    s_lshl_b32 s39, s39, 11
    s_add_u32 s38, s38, s39
    s_lshl_b32 s39, s32, 9
    s_add_u32 s38, s38, s39
    s_add_u32 s38, s38, 59768832
    buffer_store_dwordx4 v[52:55], v14, s[12:15], s38 offen sc1
mega_kernel_p0_qkv_fin:
    s_and_b32 s38, s33, 7
    v_lshlrev_b32 v2, 3, v0
    v_add_u32 v2, s38, v2
    s_mov_b32 s57, 589824
    s_branch mega_kernel_p0ab2
mega_kernel_p0_wo:
    s_mov_b32 s24, s70
    s_and_b32 s25, s71, 0xffff
    s_mov_b32 s26, 524288
    s_mov_b32 s27, 0x00020000
    s_sub_u32 s31, s2, 48
    s_and_b32 s33, s31, 7
    s_lshr_b32 s32, s31, 3
    v_mul_u32_u24 v10, 1024, v2
    v_lshl_add_u32 v10, v3, 4, v10
    s_mul_i32 s34, s32, 262144
    s_mul_i32 s35, s30, 65536
    s_add_u32 s34, s34, s35
    s_lshl_b32 s35, s33, 7
    s_add_u32 s34, s34, s35
    s_lshl_b32 s36, s30, 13
    s_add_u32 s36, s36, 65536
    s_add_u32 m0, s36, 0
    s_add_u32 s37, s34, 0
    buffer_load_dwordx4 v10, s[24:27], s37 offen lds
    s_add_u32 m0, s36, 1024
    s_add_u32 s37, s34, 8192
    buffer_load_dwordx4 v10, s[24:27], s37 offen lds
    s_add_u32 m0, s36, 2048
    s_add_u32 s37, s34, 16384
    buffer_load_dwordx4 v10, s[24:27], s37 offen lds
    s_add_u32 m0, s36, 3072
    s_add_u32 s37, s34, 24576
    buffer_load_dwordx4 v10, s[24:27], s37 offen lds
    s_add_u32 m0, s36, 4096
    s_add_u32 s37, s34, 32768
    buffer_load_dwordx4 v10, s[24:27], s37 offen lds
    s_add_u32 m0, s36, 5120
    s_add_u32 s37, s34, 40960
    buffer_load_dwordx4 v10, s[24:27], s37 offen lds
    s_add_u32 m0, s36, 6144
    s_add_u32 s37, s34, 49152
    buffer_load_dwordx4 v10, s[24:27], s37 offen lds
    s_add_u32 m0, s36, 7168
    s_add_u32 s37, s34, 57344
    buffer_load_dwordx4 v10, s[24:27], s37 offen lds
    v_lshl_add_u32 v11, v4, 2, v5
    v_lshlrev_b32 v11, 7, v11
    v_lshl_add_u32 v11, v6, 5, v11
    v_lshl_add_u32 v11, v7, 3, v11
    v_add_u32 v11, s36, v11
    s_mul_i32 s38, s33, 65536
    s_mul_i32 s39, s32, 32768
    s_add_u32 s38, s38, s39
    s_mul_i32 s39, s30, 8192
    s_add_u32 s38, s38, s39
    s_add_u32 s38, s38, 52428800
    s_waitcnt vmcnt(0)
    ds_read_b64_tr_b16 v[16:17], v11 offset:0
    ds_read_b64_tr_b16 v[18:19], v11 offset:1024
    ds_read_b64_tr_b16 v[20:21], v11 offset:64
    ds_read_b64_tr_b16 v[22:23], v11 offset:1088
    ds_read_b64_tr_b16 v[24:25], v11 offset:2048
    ds_read_b64_tr_b16 v[26:27], v11 offset:3072
    ds_read_b64_tr_b16 v[28:29], v11 offset:2112
    ds_read_b64_tr_b16 v[30:31], v11 offset:3136
    ds_read_b64_tr_b16 v[32:33], v11 offset:4096
    ds_read_b64_tr_b16 v[34:35], v11 offset:5120
    ds_read_b64_tr_b16 v[36:37], v11 offset:4160
    ds_read_b64_tr_b16 v[38:39], v11 offset:5184
    ds_read_b64_tr_b16 v[40:41], v11 offset:6144
    ds_read_b64_tr_b16 v[42:43], v11 offset:7168
    ds_read_b64_tr_b16 v[44:45], v11 offset:6208
    ds_read_b64_tr_b16 v[46:47], v11 offset:7232
    s_waitcnt lgkmcnt(0)
    s_add_u32 s39, s38, 0
    buffer_store_dwordx4 v[16:19], v8, s[12:15], s39 offen offset:0 sc1
    buffer_store_dwordx4 v[20:23], v8, s[12:15], s39 offen offset:1024 sc1
    s_nop 1
    s_add_u32 s39, s38, 2048
    buffer_store_dwordx4 v[24:27], v8, s[12:15], s39 offen offset:0 sc1
    buffer_store_dwordx4 v[28:31], v8, s[12:15], s39 offen offset:1024 sc1
    s_nop 1
    s_add_u32 s39, s38, 4096
    buffer_store_dwordx4 v[32:35], v8, s[12:15], s39 offen offset:0 sc1
    buffer_store_dwordx4 v[36:39], v8, s[12:15], s39 offen offset:1024 sc1
    s_nop 1
    s_add_u32 s39, s38, 6144
    buffer_store_dwordx4 v[40:43], v8, s[12:15], s39 offen offset:0 sc1
    buffer_store_dwordx4 v[44:47], v8, s[12:15], s39 offen offset:1024 sc1
    s_barrier
mega_kernel_p0_wo_fin:
    s_and_b32 s38, s33, 7
    v_lshlrev_b32 v2, 3, v0
    v_add_u32 v2, s38, v2
    s_mov_b32 s57, 622592
    s_branch mega_kernel_p0ab2
mega_kernel_p0ab2:
    s_cmp_lg_u32 s19, 0
    s_cbranch_scc1 mega_kernel_p0nc7
    s_sub_u32 s40, s2, 64
    s_cmp_ge_u32 s40, 16
    s_cbranch_scc1 mega_kernel_p0nf8
    s_lshl_b32 s40, s40, 2
    v_mov_b32 v5, 1
    v_mov_b32 v4, 0
    s_mov_b32 exec_lo, 1
    s_mov_b32 exec_hi, 0
    buffer_atomic_add v5, v4, s[80:83], 0 offen sc1
    s_mov_b64 exec, -1
mega_kernel_p0nf8:
    s_cmp_lt_u32 s2, 64
    s_cbranch_scc1 mega_kernel_p0nd9
    s_sleep 40
mega_kernel_p0nd9:
    s_waitcnt vmcnt(0)
    v_mov_b32 v4, 0
    s_mov_b32 s49, 0x4000
mega_kernel_p0lp4:
    buffer_load_dword v5, v4, s[80:83], 0 offen sc1
    s_waitcnt vmcnt(0)
    v_cmp_ne_u32 s[50:51], 16, v5
    s_nop 0
    s_cmp_eq_u64 s[50:51], 0
    s_cbranch_scc1 mega_kernel_p0nc7
    s_sleep 12
    s_sub_u32 s49, s49, 1
    s_cmp_lg_u32 s49, 0
    s_cbranch_scc1 mega_kernel_p0lp4
mega_kernel_p0nc7:
    s_waitcnt vmcnt(0)
    s_barrier
    s_cmp_lg_u32 s19, 0
    s_cbranch_scc1 mega_kernel_p0ns3
    s_movk_i32 s41, 0x100
    v_cmp_gt_u32 s[42:43], s41, v2
    v_lshlrev_b32 v2, 7, v2
    v_mov_b32 v3, 1
    s_add_u32 s40, s17, s57
    s_mov_b32 exec_lo, s42
    s_mov_b32 exec_hi, 0
    buffer_atomic_add v3, v2, s[12:15], s40 offen sc1
    s_mov_b64 exec, -1
mega_kernel_p0ns3:
mega_kernel_ltop:
    s_and_b32 s30, s19, 1
    s_cmp_ge_u32 s19, 2
    s_cbranch_scc1 mega_kernel_la10
    s_mul_i32 s39, s23, 196608
    s_lshl_b32 s43, s30, 13
    s_add_u32 s39, s39, s43
    s_add_u32 s39, s39, 50331648
    s_cmp_lg_u32 s18, 0
    s_cbranch_scc1 mega_kernel_p1wp12
    s_lshl_b32 s40, s22, 3
    s_add_u32 s40, s40, s23
    s_lshl_b32 s40, s40, 7
    s_add_u32 s40, s40, 61407232
    v_mov_b32 v2, 0
    s_mov_b32 s49, 0x4000
mega_kernel_pl13:
    buffer_load_dword v28, v2, s[12:15], s40 offen sc1
    s_waitcnt vmcnt(0)
    v_readfirstlane_b32 s50, v28
    s_nop 0
    s_cmp_ge_u32 s50, 6
    s_cbranch_scc1 mega_kernel_pd14
    s_sleep 1
    s_sub_u32 s49, s49, 1
    s_cmp_lg_u32 s49, 0
    s_cbranch_scc1 mega_kernel_pl13
mega_kernel_pd14:
mega_kernel_p1wp12:
    s_add_u32 m0, s43, 65536
    s_add_u32 s42, s39, 0
    buffer_load_dwordx4 v1, s[12:15], s42 offen offset:0 sc1 lds
    buffer_load_dwordx4 v1, s[12:15], s42 offen offset:1024 sc1 lds
    buffer_load_dwordx4 v1, s[12:15], s42 offen offset:2048 sc1 lds
    buffer_load_dwordx4 v1, s[12:15], s42 offen offset:3072 sc1 lds
    s_add_u32 m0, s43, 69632
    s_add_u32 s42, s39, 4096
    buffer_load_dwordx4 v1, s[12:15], s42 offen offset:0 sc1 lds
    buffer_load_dwordx4 v1, s[12:15], s42 offen offset:1024 sc1 lds
    buffer_load_dwordx4 v1, s[12:15], s42 offen offset:2048 sc1 lds
    buffer_load_dwordx4 v1, s[12:15], s42 offen offset:3072 sc1 lds
    s_add_u32 m0, s43, 81920
    s_add_u32 s42, s39, 16384
    buffer_load_dwordx4 v1, s[12:15], s42 offen offset:0 sc1 lds
    buffer_load_dwordx4 v1, s[12:15], s42 offen offset:1024 sc1 lds
    buffer_load_dwordx4 v1, s[12:15], s42 offen offset:2048 sc1 lds
    buffer_load_dwordx4 v1, s[12:15], s42 offen offset:3072 sc1 lds
    s_add_u32 m0, s43, 86016
    s_add_u32 s42, s39, 20480
    buffer_load_dwordx4 v1, s[12:15], s42 offen offset:0 sc1 lds
    buffer_load_dwordx4 v1, s[12:15], s42 offen offset:1024 sc1 lds
    buffer_load_dwordx4 v1, s[12:15], s42 offen offset:2048 sc1 lds
    buffer_load_dwordx4 v1, s[12:15], s42 offen offset:3072 sc1 lds
    s_mul_i32 s47, s30, 3072
    s_add_u32 m0, s47, 155648
    s_lshl_b32 s42, s23, 13
    s_add_u32 s42, s42, s47
    s_add_u32 s42, s42, 59768832
    buffer_load_dwordx4 v1, s[12:15], s42 offen offset:0 sc1 lds
    buffer_load_dwordx4 v1, s[12:15], s42 offen offset:1024 sc1 lds
    buffer_load_dwordx4 v1, s[12:15], s42 offen offset:2048 sc1 lds
    s_add_u32 m0, s43, 98304
    s_add_u32 s42, s39, 32768
    buffer_load_dwordx4 v1, s[12:15], s42 offen offset:0 sc1 lds
    buffer_load_dwordx4 v1, s[12:15], s42 offen offset:1024 sc1 lds
    buffer_load_dwordx4 v1, s[12:15], s42 offen offset:2048 sc1 lds
    buffer_load_dwordx4 v1, s[12:15], s42 offen offset:3072 sc1 lds
    s_add_u32 m0, s43, 102400
    s_add_u32 s42, s39, 36864
    buffer_load_dwordx4 v1, s[12:15], s42 offen offset:0 sc1 lds
    buffer_load_dwordx4 v1, s[12:15], s42 offen offset:1024 sc1 lds
    buffer_load_dwordx4 v1, s[12:15], s42 offen offset:2048 sc1 lds
    buffer_load_dwordx4 v1, s[12:15], s42 offen offset:3072 sc1 lds
    s_add_u32 m0, s43, 114688
    s_add_u32 s42, s39, 49152
    buffer_load_dwordx4 v1, s[12:15], s42 offen offset:0 sc1 lds
    buffer_load_dwordx4 v1, s[12:15], s42 offen offset:1024 sc1 lds
    buffer_load_dwordx4 v1, s[12:15], s42 offen offset:2048 sc1 lds
    buffer_load_dwordx4 v1, s[12:15], s42 offen offset:3072 sc1 lds
    s_add_u32 m0, s43, 118784
    s_add_u32 s42, s39, 53248
    buffer_load_dwordx4 v1, s[12:15], s42 offen offset:0 sc1 lds
    buffer_load_dwordx4 v1, s[12:15], s42 offen offset:1024 sc1 lds
    buffer_load_dwordx4 v1, s[12:15], s42 offen offset:2048 sc1 lds
    buffer_load_dwordx4 v1, s[12:15], s42 offen offset:3072 sc1 lds
    s_add_u32 m0, s43, 131072
    s_add_u32 s42, s39, 65536
    buffer_load_dwordx4 v1, s[12:15], s42 offen offset:0 sc1 lds
    buffer_load_dwordx4 v1, s[12:15], s42 offen offset:1024 sc1 lds
    buffer_load_dwordx4 v1, s[12:15], s42 offen offset:2048 sc1 lds
    buffer_load_dwordx4 v1, s[12:15], s42 offen offset:3072 sc1 lds
    s_add_u32 m0, s43, 135168
    s_add_u32 s42, s39, 69632
    buffer_load_dwordx4 v1, s[12:15], s42 offen offset:0 sc1 lds
    buffer_load_dwordx4 v1, s[12:15], s42 offen offset:1024 sc1 lds
    buffer_load_dwordx4 v1, s[12:15], s42 offen offset:2048 sc1 lds
    buffer_load_dwordx4 v1, s[12:15], s42 offen offset:3072 sc1 lds
    s_waitcnt vmcnt(35)
    s_barrier
    s_waitcnt vmcnt(24)
    s_barrier
    s_waitcnt vmcnt(16)
    s_barrier
    s_add_u32 m0, s43, 65536
    s_add_u32 s42, s39, 81920
    buffer_load_dwordx4 v1, s[12:15], s42 offen offset:0 sc1 lds
    buffer_load_dwordx4 v1, s[12:15], s42 offen offset:1024 sc1 lds
    buffer_load_dwordx4 v1, s[12:15], s42 offen offset:2048 sc1 lds
    buffer_load_dwordx4 v1, s[12:15], s42 offen offset:3072 sc1 lds
    s_add_u32 m0, s43, 69632
    s_add_u32 s42, s39, 86016
    buffer_load_dwordx4 v1, s[12:15], s42 offen offset:0 sc1 lds
    buffer_load_dwordx4 v1, s[12:15], s42 offen offset:1024 sc1 lds
    buffer_load_dwordx4 v1, s[12:15], s42 offen offset:2048 sc1 lds
    buffer_load_dwordx4 v1, s[12:15], s42 offen offset:3072 sc1 lds
    s_waitcnt vmcnt(16)
    s_barrier
    s_add_u32 m0, s43, 81920
    s_add_u32 s42, s39, 98304
    buffer_load_dwordx4 v1, s[12:15], s42 offen offset:0 sc1 lds
    buffer_load_dwordx4 v1, s[12:15], s42 offen offset:1024 sc1 lds
    buffer_load_dwordx4 v1, s[12:15], s42 offen offset:2048 sc1 lds
    buffer_load_dwordx4 v1, s[12:15], s42 offen offset:3072 sc1 lds
    s_add_u32 m0, s43, 86016
    s_add_u32 s42, s39, 102400
    buffer_load_dwordx4 v1, s[12:15], s42 offen offset:0 sc1 lds
    buffer_load_dwordx4 v1, s[12:15], s42 offen offset:1024 sc1 lds
    buffer_load_dwordx4 v1, s[12:15], s42 offen offset:2048 sc1 lds
    buffer_load_dwordx4 v1, s[12:15], s42 offen offset:3072 sc1 lds
    s_waitcnt vmcnt(16)
    s_barrier
    s_add_u32 m0, s43, 98304
    s_add_u32 s42, s39, 114688
    buffer_load_dwordx4 v1, s[12:15], s42 offen offset:0 sc1 lds
    buffer_load_dwordx4 v1, s[12:15], s42 offen offset:1024 sc1 lds
    buffer_load_dwordx4 v1, s[12:15], s42 offen offset:2048 sc1 lds
    buffer_load_dwordx4 v1, s[12:15], s42 offen offset:3072 sc1 lds
    s_add_u32 m0, s43, 102400
    s_add_u32 s42, s39, 118784
    buffer_load_dwordx4 v1, s[12:15], s42 offen offset:0 sc1 lds
    buffer_load_dwordx4 v1, s[12:15], s42 offen offset:1024 sc1 lds
    buffer_load_dwordx4 v1, s[12:15], s42 offen offset:2048 sc1 lds
    buffer_load_dwordx4 v1, s[12:15], s42 offen offset:3072 sc1 lds
    s_waitcnt vmcnt(16)
    s_barrier
    s_add_u32 m0, s43, 114688
    s_add_u32 s42, s39, 131072
    buffer_load_dwordx4 v1, s[12:15], s42 offen offset:0 sc1 lds
    buffer_load_dwordx4 v1, s[12:15], s42 offen offset:1024 sc1 lds
    buffer_load_dwordx4 v1, s[12:15], s42 offen offset:2048 sc1 lds
    buffer_load_dwordx4 v1, s[12:15], s42 offen offset:3072 sc1 lds
    s_add_u32 m0, s43, 118784
    s_add_u32 s42, s39, 135168
    buffer_load_dwordx4 v1, s[12:15], s42 offen offset:0 sc1 lds
    buffer_load_dwordx4 v1, s[12:15], s42 offen offset:1024 sc1 lds
    buffer_load_dwordx4 v1, s[12:15], s42 offen offset:2048 sc1 lds
    buffer_load_dwordx4 v1, s[12:15], s42 offen offset:3072 sc1 lds
    s_waitcnt vmcnt(16)
    s_barrier
    s_add_u32 m0, s43, 131072
    s_add_u32 s42, s39, 147456
    buffer_load_dwordx4 v1, s[12:15], s42 offen offset:0 sc1 lds
    buffer_load_dwordx4 v1, s[12:15], s42 offen offset:1024 sc1 lds
    buffer_load_dwordx4 v1, s[12:15], s42 offen offset:2048 sc1 lds
    buffer_load_dwordx4 v1, s[12:15], s42 offen offset:3072 sc1 lds
    s_add_u32 m0, s43, 135168
    s_add_u32 s42, s39, 151552
    buffer_load_dwordx4 v1, s[12:15], s42 offen offset:0 sc1 lds
    buffer_load_dwordx4 v1, s[12:15], s42 offen offset:1024 sc1 lds
    buffer_load_dwordx4 v1, s[12:15], s42 offen offset:2048 sc1 lds
    buffer_load_dwordx4 v1, s[12:15], s42 offen offset:3072 sc1 lds
    s_waitcnt vmcnt(16)
    s_barrier
    s_add_u32 m0, s43, 65536
    s_add_u32 s42, s39, 163840
    buffer_load_dwordx4 v1, s[12:15], s42 offen offset:0 sc1 lds
    buffer_load_dwordx4 v1, s[12:15], s42 offen offset:1024 sc1 lds
    buffer_load_dwordx4 v1, s[12:15], s42 offen offset:2048 sc1 lds
    buffer_load_dwordx4 v1, s[12:15], s42 offen offset:3072 sc1 lds
    s_add_u32 m0, s43, 69632
    s_add_u32 s42, s39, 167936
    buffer_load_dwordx4 v1, s[12:15], s42 offen offset:0 sc1 lds
    buffer_load_dwordx4 v1, s[12:15], s42 offen offset:1024 sc1 lds
    buffer_load_dwordx4 v1, s[12:15], s42 offen offset:2048 sc1 lds
    buffer_load_dwordx4 v1, s[12:15], s42 offen offset:3072 sc1 lds
    s_waitcnt vmcnt(16)
    s_barrier
    s_add_u32 m0, s43, 81920
    s_add_u32 s42, s39, 180224
    buffer_load_dwordx4 v1, s[12:15], s42 offen offset:0 sc1 lds
    buffer_load_dwordx4 v1, s[12:15], s42 offen offset:1024 sc1 lds
    buffer_load_dwordx4 v1, s[12:15], s42 offen offset:2048 sc1 lds
    buffer_load_dwordx4 v1, s[12:15], s42 offen offset:3072 sc1 lds
    s_add_u32 m0, s43, 86016
    s_add_u32 s42, s39, 184320
    buffer_load_dwordx4 v1, s[12:15], s42 offen offset:0 sc1 lds
    buffer_load_dwordx4 v1, s[12:15], s42 offen offset:1024 sc1 lds
    buffer_load_dwordx4 v1, s[12:15], s42 offen offset:2048 sc1 lds
    buffer_load_dwordx4 v1, s[12:15], s42 offen offset:3072 sc1 lds
    s_waitcnt vmcnt(16)
    s_barrier
    s_waitcnt vmcnt(8)
    s_barrier
    s_waitcnt vmcnt(0)
    s_barrier
    s_barrier
    s_branch mega_kernel_le11
mega_kernel_la10:
    s_lshl_b32 s37, s22, 1
    s_add_u32 s37, s37, s30
    s_lshl_b32 s44, s37, 15
    s_add_u32 s46, s44, 18874368
    s_add_u32 s46, s46, s16
    s_lshl_b32 s45, s30, 12
    s_cmp_eq_u32 s18, 0
    s_cbranch_scc1 mega_kernel_p1np15
    s_lshl_b32 s40, s22, 3
    s_add_u32 s40, s40, s23
    s_lshl_b32 s40, s40, 7
    s_add_u32 s40, s40, s17
    s_add_u32 s40, s40, 131072
    v_mov_b32 v2, 0
    s_mov_b32 s49, 0x4000
mega_kernel_pl16:
    buffer_load_dword v28, v2, s[12:15], s40 offen sc1
    s_waitcnt vmcnt(0)
    v_readfirstlane_b32 s50, v28
    s_nop 0
    s_cmp_ge_u32 s50, 8
    s_cbranch_scc1 mega_kernel_pd17
    s_sleep 1
    s_sub_u32 s49, s49, 1
    s_cmp_lg_u32 s49, 0
    s_cbranch_scc1 mega_kernel_pl16
mega_kernel_pd17:
    s_add_u32 m0, s45, 0
    s_add_u32 s42, s46, 0
    buffer_load_dwordx4 v1, s[12:15], s42 offen offset:0 sc1 lds
    buffer_load_dwordx4 v1, s[12:15], s42 offen offset:1024 sc1 lds
    buffer_load_dwordx4 v1, s[12:15], s42 offen offset:2048 sc1 lds
    buffer_load_dwordx4 v1, s[12:15], s42 offen offset:3072 sc1 lds
    s_add_u32 m0, s45, 8192
    s_add_u32 s42, s46, 4096
    buffer_load_dwordx4 v1, s[12:15], s42 offen offset:0 sc1 lds
    buffer_load_dwordx4 v1, s[12:15], s42 offen offset:1024 sc1 lds
    buffer_load_dwordx4 v1, s[12:15], s42 offen offset:2048 sc1 lds
    buffer_load_dwordx4 v1, s[12:15], s42 offen offset:3072 sc1 lds
    s_add_u32 m0, s45, 147456
    s_lshl_b32 s42, s37, 12
    s_add_u32 s42, s42, 20971520
    s_add_u32 s42, s42, s16
    buffer_load_dwordx4 v1, s[12:15], s42 offen offset:0 sc1 lds
    buffer_load_dwordx4 v1, s[12:15], s42 offen offset:1024 sc1 lds
    buffer_load_dwordx4 v1, s[12:15], s42 offen offset:2048 sc1 lds
    buffer_load_dwordx4 v1, s[12:15], s42 offen offset:3072 sc1 lds
    s_add_u32 m0, s45, 16384
    s_add_u32 s42, s46, 8192
    buffer_load_dwordx4 v1, s[12:15], s42 offen offset:0 sc1 lds
    buffer_load_dwordx4 v1, s[12:15], s42 offen offset:1024 sc1 lds
    buffer_load_dwordx4 v1, s[12:15], s42 offen offset:2048 sc1 lds
    buffer_load_dwordx4 v1, s[12:15], s42 offen offset:3072 sc1 lds
    s_add_u32 m0, s45, 24576
    s_add_u32 s42, s46, 12288
    buffer_load_dwordx4 v1, s[12:15], s42 offen offset:0 sc1 lds
    buffer_load_dwordx4 v1, s[12:15], s42 offen offset:1024 sc1 lds
    buffer_load_dwordx4 v1, s[12:15], s42 offen offset:2048 sc1 lds
    buffer_load_dwordx4 v1, s[12:15], s42 offen offset:3072 sc1 lds
    s_add_u32 m0, s45, 32768
    s_add_u32 s42, s46, 16384
    buffer_load_dwordx4 v1, s[12:15], s42 offen offset:0 sc1 lds
    buffer_load_dwordx4 v1, s[12:15], s42 offen offset:1024 sc1 lds
    buffer_load_dwordx4 v1, s[12:15], s42 offen offset:2048 sc1 lds
    buffer_load_dwordx4 v1, s[12:15], s42 offen offset:3072 sc1 lds
    s_add_u32 m0, s45, 40960
    s_add_u32 s42, s46, 20480
    buffer_load_dwordx4 v1, s[12:15], s42 offen offset:0 sc1 lds
    buffer_load_dwordx4 v1, s[12:15], s42 offen offset:1024 sc1 lds
    buffer_load_dwordx4 v1, s[12:15], s42 offen offset:2048 sc1 lds
    buffer_load_dwordx4 v1, s[12:15], s42 offen offset:3072 sc1 lds
    s_add_u32 m0, s45, 49152
    s_add_u32 s42, s46, 24576
    buffer_load_dwordx4 v1, s[12:15], s42 offen offset:0 sc1 lds
    buffer_load_dwordx4 v1, s[12:15], s42 offen offset:1024 sc1 lds
    buffer_load_dwordx4 v1, s[12:15], s42 offen offset:2048 sc1 lds
    buffer_load_dwordx4 v1, s[12:15], s42 offen offset:3072 sc1 lds
    s_add_u32 m0, s45, 57344
    s_add_u32 s42, s46, 28672
    buffer_load_dwordx4 v1, s[12:15], s42 offen offset:0 sc1 lds
    buffer_load_dwordx4 v1, s[12:15], s42 offen offset:1024 sc1 lds
    buffer_load_dwordx4 v1, s[12:15], s42 offen offset:2048 sc1 lds
    buffer_load_dwordx4 v1, s[12:15], s42 offen offset:3072 sc1 lds
mega_kernel_p1np15:
    s_waitcnt vmcnt(32)
    s_barrier
    s_waitcnt vmcnt(24)
    s_barrier
    s_waitcnt vmcnt(20)
    s_barrier
    s_waitcnt vmcnt(16)
    s_barrier
    s_waitcnt vmcnt(12)
    s_barrier
    s_waitcnt vmcnt(8)
    s_barrier
    s_waitcnt vmcnt(4)
    s_barrier
    s_waitcnt vmcnt(0)
    s_barrier
    s_waitcnt vmcnt(0)
    s_barrier
    s_waitcnt vmcnt(0)
    s_barrier
    s_waitcnt vmcnt(0)
    s_barrier
    s_waitcnt vmcnt(0)
    s_barrier
    s_barrier
mega_kernel_le11:
    s_lshl_b32 s33, s23, 2
    s_add_u32 s33, s33, s19
    s_lshl_b32 s33, s33, 16
    s_add_u32 s33, s33, s16
    s_add_u32 s33, s33, 2097152
    s_lshl_b32 s34, s22, 1
    s_sub_u32 s34, s34, 8
    s_mul_i32 s35, s19, 10240
    s_add_i32 s36, s34, 0
    s_max_i32 s36, s36, 0
    s_lshl_b32 s36, s36, 10
    s_add_u32 s36, s36, s33
    s_add_i32 s37, s34, 1
    s_max_i32 s37, s37, 0
    s_lshl_b32 s37, s37, 10
    s_add_u32 s37, s37, s33
    s_add_i32 s38, s34, 2
    s_max_i32 s38, s38, 0
    s_lshl_b32 s38, s38, 10
    s_add_u32 s38, s38, s33
    s_add_i32 s39, s34, 3
    s_max_i32 s39, s39, 0
    s_lshl_b32 s39, s39, 10
    s_add_u32 s39, s39, s33
    s_add_i32 s40, s34, 4
    s_max_i32 s40, s40, 0
    s_lshl_b32 s40, s40, 10
    s_add_u32 s40, s40, s33
    s_add_i32 s41, s34, 5
    s_max_i32 s41, s41, 0
    s_lshl_b32 s41, s41, 10
    s_add_u32 s41, s41, s33
    s_add_i32 s42, s34, 6
    s_max_i32 s42, s42, 0
    s_lshl_b32 s42, s42, 10
    s_add_u32 s42, s42, s33
    s_add_i32 s43, s34, 7
    s_max_i32 s43, s43, 0
    s_lshl_b32 s43, s43, 10
    s_add_u32 s43, s43, s33
    s_add_i32 s44, s34, 8
    s_max_i32 s44, s44, 0
    s_lshl_b32 s44, s44, 10
    s_add_u32 s44, s44, s33
    s_add_i32 s45, s34, 9
    s_max_i32 s45, s45, 0
    s_lshl_b32 s45, s45, 10
    s_add_u32 s45, s45, s33
    s_lshl_b32 s46, s22, 3
    s_add_u32 s46, s46, s23
    s_lshl_b32 s46, s46, 7
    s_add_u32 s46, s46, s17
    s_min_u32 s48, s22, 4
    s_add_u32 s48, s48, 1
    s_lshl_b32 s48, s48, 2
    v_mov_b32 v2, 0
    s_mov_b32 s49, 0x4000
mega_kernel_pl23:
    buffer_load_dword v28, v2, s[12:15], s46 offen sc1
    s_waitcnt vmcnt(0)
    v_readfirstlane_b32 s50, v28
    s_nop 0
    s_cmp_ge_u32 s50, s48
    s_cbranch_scc1 mega_kernel_pd24
    s_sleep 1
    s_sub_u32 s49, s49, 1
    s_cmp_lg_u32 s49, 0
    s_cbranch_scc1 mega_kernel_pl23
mega_kernel_pd24:
    s_add_u32 m0, s35, 0
    s_nop 0
    buffer_load_dwordx4 v1, s[12:15], s36 offen sc1 lds
    s_add_u32 m0, s35, 1024
    s_nop 0
    buffer_load_dwordx4 v1, s[12:15], s37 offen sc1 lds
    s_add_u32 m0, s35, 2048
    s_nop 0
    buffer_load_dwordx4 v1, s[12:15], s38 offen sc1 lds
    s_add_u32 m0, s35, 3072
    s_nop 0
    buffer_load_dwordx4 v1, s[12:15], s39 offen sc1 lds
    s_add_u32 m0, s35, 4096
    s_nop 0
    buffer_load_dwordx4 v1, s[12:15], s40 offen sc1 lds
    s_add_u32 m0, s35, 5120
    s_nop 0
    buffer_load_dwordx4 v1, s[12:15], s41 offen sc1 lds
    s_add_u32 m0, s35, 6144
    s_nop 0
    buffer_load_dwordx4 v1, s[12:15], s42 offen sc1 lds
    s_add_u32 m0, s35, 7168
    s_nop 0
    buffer_load_dwordx4 v1, s[12:15], s43 offen sc1 lds
    s_add_u32 m0, s35, 8192
    s_nop 0
    buffer_load_dwordx4 v1, s[12:15], s44 offen sc1 lds
    s_add_u32 m0, s35, 9216
    s_nop 0
    buffer_load_dwordx4 v1, s[12:15], s45 offen sc1 lds
    s_add_u32 m0, s35, 40960
    s_add_u32 s36, s36, 2097152
    buffer_load_dwordx4 v1, s[12:15], s36 offen sc1 lds
    s_add_u32 m0, s35, 41984
    s_add_u32 s37, s37, 2097152
    buffer_load_dwordx4 v1, s[12:15], s37 offen sc1 lds
    s_add_u32 m0, s35, 43008
    s_add_u32 s38, s38, 2097152
    buffer_load_dwordx4 v1, s[12:15], s38 offen sc1 lds
    s_add_u32 m0, s35, 44032
    s_add_u32 s39, s39, 2097152
    buffer_load_dwordx4 v1, s[12:15], s39 offen sc1 lds
    s_add_u32 m0, s35, 45056
    s_add_u32 s40, s40, 2097152
    buffer_load_dwordx4 v1, s[12:15], s40 offen sc1 lds
    s_add_u32 m0, s35, 46080
    s_add_u32 s41, s41, 2097152
    buffer_load_dwordx4 v1, s[12:15], s41 offen sc1 lds
    s_add_u32 m0, s35, 47104
    s_add_u32 s42, s42, 2097152
    buffer_load_dwordx4 v1, s[12:15], s42 offen sc1 lds
    s_add_u32 m0, s35, 48128
    s_add_u32 s43, s43, 2097152
    buffer_load_dwordx4 v1, s[12:15], s43 offen sc1 lds
    s_add_u32 m0, s35, 49152
    s_add_u32 s44, s44, 2097152
    buffer_load_dwordx4 v1, s[12:15], s44 offen sc1 lds
    s_add_u32 m0, s35, 50176
    s_add_u32 s45, s45, 2097152
    buffer_load_dwordx4 v1, s[12:15], s45 offen sc1 lds
    s_cmp_lg_u32 s18, 0
    s_cbranch_scc1 mega_kernel_p2np26
    s_cmp_ge_u32 s2, 168
    s_cbranch_scc1 mega_kernel_p2np26
    v_mov_b32 v56, 161792
    v_mov_b32 v58, 0
    v_mov_b32 v59, 0
    ds_write_b64 v56, v[58:59]
    s_mov_b32 s30, s19
    v_lshlrev_b32 v8, 4, v0
    v_mov_b32 v9, 0x3f803f80
    v_lshrrev_b32 v2, 3, v0
    v_and_b32 v3, 7, v0
    v_lshrrev_b32 v4, 5, v0
    v_bfe_u32 v5, v0, 2, 2
    v_bfe_u32 v6, v0, 4, 1
    v_and_b32 v7, 3, v0
    s_cmp_lt_u32 s2, 112
    s_cbranch_scc1 mega_kernel_pa_gu
    s_cmp_lt_u32 s2, 168
    s_cbranch_scc1 mega_kernel_pa_wd
    v_mov_b32 v2, 0x100
    s_mov_b32 s57, 589824
    s_branch mega_kernel_p2a127
mega_kernel_pa_wd:
    s_mov_b32 s24, s76
    s_and_b32 s25, s77, 0xffff
    s_mov_b32 s26, 1835008
    s_mov_b32 s27, 0x00020000
    s_sub_u32 s31, s2, 112
    s_and_b32 s33, s31, 7
    s_lshr_b32 s32, s31, 3
    v_mul_u32_u24 v10, 1024, v2
    v_lshl_add_u32 v10, v3, 4, v10
    s_mul_i32 s34, s32, 262144
    s_mul_i32 s35, s30, 65536
    s_add_u32 s34, s34, s35
    s_lshl_b32 s35, s33, 7
    s_add_u32 s34, s34, s35
    s_lshl_b32 s36, s30, 13
    s_add_u32 s36, s36, 122880
    s_add_u32 m0, s36, 0
    s_add_u32 s37, s34, 0
    buffer_load_dwordx4 v10, s[24:27], s37 offen lds
    s_add_u32 m0, s36, 1024
    s_add_u32 s37, s34, 8192
    buffer_load_dwordx4 v10, s[24:27], s37 offen lds
    s_add_u32 m0, s36, 2048
    s_add_u32 s37, s34, 16384
    buffer_load_dwordx4 v10, s[24:27], s37 offen lds
    s_add_u32 m0, s36, 3072
    s_add_u32 s37, s34, 24576
    buffer_load_dwordx4 v10, s[24:27], s37 offen lds
    s_add_u32 m0, s36, 4096
    s_add_u32 s37, s34, 32768
    buffer_load_dwordx4 v10, s[24:27], s37 offen lds
    s_add_u32 m0, s36, 5120
    s_add_u32 s37, s34, 40960
    buffer_load_dwordx4 v10, s[24:27], s37 offen lds
    s_add_u32 m0, s36, 6144
    s_add_u32 s37, s34, 49152
    buffer_load_dwordx4 v10, s[24:27], s37 offen lds
    s_add_u32 m0, s36, 7168
    s_add_u32 s37, s34, 57344
    buffer_load_dwordx4 v10, s[24:27], s37 offen lds
    s_branch mega_kernel_p2a127
mega_kernel_pa_gu:
    s_mov_b32 s24, s72
    s_and_b32 s25, s73, 0xffff
    s_mov_b32 s26, 1835008
    s_mov_b32 s27, 0x00020000
    s_mov_b32 s64, s74
    s_and_b32 s65, s75, 0xffff
    s_mov_b32 s66, 1835008
    s_mov_b32 s67, 0x00020000
    s_and_b32 s32, s2, 3
    s_lshr_b32 s33, s2, 2
    v_mul_u32_u24 v10, 3584, v2
    v_lshl_add_u32 v10, v3, 4, v10
    s_mul_i32 s34, s32, 458752
    s_mul_i32 s35, s30, 114688
    s_add_u32 s34, s34, s35
    s_lshl_b32 s35, s33, 7
    s_add_u32 s34, s34, s35
    s_lshl_b32 s36, s30, 13
    s_add_u32 s36, s36, 122880
    s_add_u32 s37, s34, 0
    s_add_u32 m0, s36, 0
    s_nop 0
    buffer_load_dwordx4 v10, s[24:27], s37 offen lds
    s_add_u32 m0, s36, 4096
    s_nop 0
    buffer_load_dwordx4 v10, s[64:67], s37 offen lds
    s_add_u32 s37, s34, 28672
    s_add_u32 m0, s36, 1024
    s_nop 0
    buffer_load_dwordx4 v10, s[24:27], s37 offen lds
    s_add_u32 m0, s36, 5120
    s_nop 0
    buffer_load_dwordx4 v10, s[64:67], s37 offen lds
    s_add_u32 s37, s34, 57344
    s_add_u32 m0, s36, 2048
    s_nop 0
    buffer_load_dwordx4 v10, s[24:27], s37 offen lds
    s_add_u32 m0, s36, 6144
    s_nop 0
    buffer_load_dwordx4 v10, s[64:67], s37 offen lds
    s_add_u32 s37, s34, 86016
    s_add_u32 m0, s36, 3072
    s_nop 0
    buffer_load_dwordx4 v10, s[24:27], s37 offen lds
    s_add_u32 m0, s36, 7168
    s_nop 0
    buffer_load_dwordx4 v10, s[64:67], s37 offen lds
    s_branch mega_kernel_p2a127
mega_kernel_p2a127:
    s_waitcnt vmcnt(18) lgkmcnt(0)
    s_barrier
    s_waitcnt vmcnt(8)
    s_barrier
    s_cmp_ge_u32 s19, 2
    s_cbranch_scc1 mega_kernel_p2w229
    s_lshl_b32 s40, s20, 3
    s_add_u32 s40, s40, s21
    s_lshl_b32 s40, s40, 7
    s_add_u32 s40, s40, 61440000
    v_mov_b32 v2, 0
    s_mov_b32 s49, 0x4000
mega_kernel_pl31:
    buffer_load_dword v28, v2, s[12:15], s40 offen sc1
    s_waitcnt vmcnt(0)
    v_readfirstlane_b32 s50, v28
    s_nop 0
    s_cmp_ge_u32 s50, 2
    s_cbranch_scc1 mega_kernel_pd32
    s_sleep 1
    s_sub_u32 s49, s49, 1
    s_cmp_lg_u32 s49, 0
    s_cbranch_scc1 mega_kernel_pl31
mega_kernel_pd32:
mega_kernel_p2w229:
    s_mov_b32 s30, s19
    v_lshlrev_b32 v8, 4, v0
    v_mov_b32 v9, 0x3f803f80
    v_lshrrev_b32 v2, 3, v0
    v_and_b32 v3, 7, v0
    v_lshrrev_b32 v4, 5, v0
    v_bfe_u32 v5, v0, 2, 2
    v_bfe_u32 v6, v0, 4, 1
    v_and_b32 v7, 3, v0
    s_cmp_lt_u32 s2, 112
    s_cbranch_scc1 mega_kernel_pb_gu
    s_cmp_lt_u32 s2, 168
    s_cbranch_scc1 mega_kernel_pb_wd
    v_mov_b32 v2, 0x100
    s_mov_b32 s57, 589824
    s_branch mega_kernel_p2a228
mega_kernel_pb_wd:
    s_mov_b32 s24, s76
    s_and_b32 s25, s77, 0xffff
    s_mov_b32 s26, 1835008
    s_mov_b32 s27, 0x00020000
    s_sub_u32 s31, s2, 112
    s_and_b32 s33, s31, 7
    s_lshr_b32 s32, s31, 3
    v_mul_u32_u24 v10, 1024, v2
    v_lshl_add_u32 v10, v3, 4, v10
    s_mul_i32 s34, s32, 262144
    s_mul_i32 s35, s30, 65536
    s_add_u32 s34, s34, s35
    s_lshl_b32 s35, s33, 7
    s_add_u32 s34, s34, s35
    s_lshl_b32 s36, s30, 13
    s_add_u32 s36, s36, 122880
    v_lshl_add_u32 v11, v4, 2, v5
    v_lshlrev_b32 v11, 7, v11
    v_lshl_add_u32 v11, v6, 5, v11
    v_lshl_add_u32 v11, v7, 3, v11
    v_add_u32 v11, s36, v11
    s_waitcnt vmcnt(0)
    ds_read_b64_tr_b16 v[16:17], v11 offset:0
    ds_read_b64_tr_b16 v[18:19], v11 offset:1024
    ds_read_b64_tr_b16 v[20:21], v11 offset:64
    ds_read_b64_tr_b16 v[22:23], v11 offset:1088
    ds_read_b64_tr_b16 v[24:25], v11 offset:2048
    ds_read_b64_tr_b16 v[26:27], v11 offset:3072
    ds_read_b64_tr_b16 v[28:29], v11 offset:2112
    ds_read_b64_tr_b16 v[30:31], v11 offset:3136
    ds_read_b64_tr_b16 v[32:33], v11 offset:4096
    ds_read_b64_tr_b16 v[34:35], v11 offset:5120
    ds_read_b64_tr_b16 v[36:37], v11 offset:4160
    ds_read_b64_tr_b16 v[38:39], v11 offset:5184
    ds_read_b64_tr_b16 v[40:41], v11 offset:6144
    ds_read_b64_tr_b16 v[42:43], v11 offset:7168
    ds_read_b64_tr_b16 v[44:45], v11 offset:6208
    ds_read_b64_tr_b16 v[46:47], v11 offset:7232
    s_waitcnt lgkmcnt(0)
    s_lshl_b32 s48, s32, 4
    s_lshl_b32 s49, s30, 2
    s_add_u32 s48, s48, s49
    s_add_u32 s48, s48, 0
    s_mul_i32 s49, s48, 9363
    s_lshr_b32 s49, s49, 16
    s_mul_i32 s50, s49, 7
    s_sub_u32 s50, s48, s50
    s_lshl_b32 s51, s49, 2
    s_add_u32 s51, s51, s50
    s_mul_i32 s52, s49, 3
    s_add_u32 s52, s52, s50
    s_add_u32 s52, s52, 60
    s_cmp_lt_u32 s50, 4
    s_cselect_b32 s51, s51, s52
    s_lshl_b32 s51, s51, 11
    s_mul_i32 s39, s33, 229376
    s_add_u32 s39, s39, s51
    s_add_u32 s39, s39, 57671680
    buffer_store_dwordx4 v[16:19], v8, s[12:15], s39 offen offset:0 sc1
    buffer_store_dwordx4 v[20:23], v8, s[12:15], s39 offen offset:1024 sc1
    s_lshl_b32 s48, s32, 4
    s_lshl_b32 s49, s30, 2
    s_add_u32 s48, s48, s49
    s_add_u32 s48, s48, 1
    s_mul_i32 s49, s48, 9363
    s_lshr_b32 s49, s49, 16
    s_mul_i32 s50, s49, 7
    s_sub_u32 s50, s48, s50
    s_lshl_b32 s51, s49, 2
    s_add_u32 s51, s51, s50
    s_mul_i32 s52, s49, 3
    s_add_u32 s52, s52, s50
    s_add_u32 s52, s52, 60
    s_cmp_lt_u32 s50, 4
    s_cselect_b32 s51, s51, s52
    s_lshl_b32 s51, s51, 11
    s_mul_i32 s39, s33, 229376
    s_add_u32 s39, s39, s51
    s_add_u32 s39, s39, 57671680
    buffer_store_dwordx4 v[24:27], v8, s[12:15], s39 offen offset:0 sc1
    buffer_store_dwordx4 v[28:31], v8, s[12:15], s39 offen offset:1024 sc1
    s_lshl_b32 s48, s32, 4
    s_lshl_b32 s49, s30, 2
    s_add_u32 s48, s48, s49
    s_add_u32 s48, s48, 2
    s_mul_i32 s49, s48, 9363
    s_lshr_b32 s49, s49, 16
    s_mul_i32 s50, s49, 7
    s_sub_u32 s50, s48, s50
    s_lshl_b32 s51, s49, 2
    s_add_u32 s51, s51, s50
    s_mul_i32 s52, s49, 3
    s_add_u32 s52, s52, s50
    s_add_u32 s52, s52, 60
    s_cmp_lt_u32 s50, 4
    s_cselect_b32 s51, s51, s52
    s_lshl_b32 s51, s51, 11
    s_mul_i32 s39, s33, 229376
    s_add_u32 s39, s39, s51
    s_add_u32 s39, s39, 57671680
    buffer_store_dwordx4 v[32:35], v8, s[12:15], s39 offen offset:0 sc1
    buffer_store_dwordx4 v[36:39], v8, s[12:15], s39 offen offset:1024 sc1
    s_lshl_b32 s48, s32, 4
    s_lshl_b32 s49, s30, 2
    s_add_u32 s48, s48, s49
    s_add_u32 s48, s48, 3
    s_mul_i32 s49, s48, 9363
    s_lshr_b32 s49, s49, 16
    s_mul_i32 s50, s49, 7
    s_sub_u32 s50, s48, s50
    s_lshl_b32 s51, s49, 2
    s_add_u32 s51, s51, s50
    s_mul_i32 s52, s49, 3
    s_add_u32 s52, s52, s50
    s_add_u32 s52, s52, 60
    s_cmp_lt_u32 s50, 4
    s_cselect_b32 s51, s51, s52
    s_lshl_b32 s51, s51, 11
    s_mul_i32 s39, s33, 229376
    s_add_u32 s39, s39, s51
    s_add_u32 s39, s39, 57671680
    buffer_store_dwordx4 v[40:43], v8, s[12:15], s39 offen offset:0 sc1
    buffer_store_dwordx4 v[44:47], v8, s[12:15], s39 offen offset:1024 sc1
mega_kernel_pb_wd_fin:
    s_and_b32 s38, s33, 7
    v_lshlrev_b32 v2, 3, v0
    v_add_u32 v2, s38, v2
    s_mov_b32 s57, 688128
    s_branch mega_kernel_p2a228
mega_kernel_pb_gu:
    s_mov_b32 s24, s72
    s_and_b32 s25, s73, 0xffff
    s_mov_b32 s26, 1835008
    s_mov_b32 s27, 0x00020000
    s_mov_b32 s64, s74
    s_and_b32 s65, s75, 0xffff
    s_mov_b32 s66, 1835008
    s_mov_b32 s67, 0x00020000
    s_and_b32 s32, s2, 3
    s_lshr_b32 s33, s2, 2
    v_mul_u32_u24 v10, 3584, v2
    v_lshl_add_u32 v10, v3, 4, v10
    s_mul_i32 s34, s32, 458752
    s_mul_i32 s35, s30, 114688
    s_add_u32 s34, s34, s35
    s_lshl_b32 s35, s33, 7
    s_add_u32 s34, s34, s35
    s_lshl_b32 s36, s30, 13
    s_add_u32 s36, s36, 122880
    v_lshl_add_u32 v11, v4, 3, v5
    v_lshlrev_b32 v11, 7, v11
    v_lshl_add_u32 v11, v6, 12, v11
    v_lshl_add_u32 v11, v7, 3, v11
    v_add_u32 v11, s36, v11
    s_lshl_b32 s38, s32, 3
    s_lshl_b32 s39, s30, 1
    s_add_u32 s38, s38, s39
    s_lshl_b32 s48, s33, 2
    s_add_u32 s48, s48, 0
    s_mul_i32 s49, s48, 9363
    s_lshr_b32 s49, s49, 16
    s_mov_b32 s40, s49
    s_mul_i32 s50, s49, 7
    s_sub_u32 s50, s48, s50
    s_cmp_lt_u32 s50, 4
    s_cselect_b32 s56, 4, 3
    s_cselect_b32 s51, 0, 126976
    s_lshl_b32 s56, s56, 10
    s_lshl_b32 s50, s50, 10
    s_add_u32 s51, s51, s50
    s_mul_i32 s49, s49, 229376
    s_add_u32 s51, s51, s49
    s_mul_i32 s49, s38, s56
    s_add_u32 s51, s51, s49
    s_add_u32 s52, s51, 53477376
    s_lshl_b32 s48, s33, 2
    s_add_u32 s48, s48, 1
    s_mul_i32 s49, s48, 9363
    s_lshr_b32 s49, s49, 16
    s_mul_i32 s50, s49, 7
    s_sub_u32 s50, s48, s50
    s_cmp_lt_u32 s50, 4
    s_cselect_b32 s57, 4, 3
    s_cselect_b32 s51, 0, 126976
    s_lshl_b32 s57, s57, 10
    s_lshl_b32 s50, s50, 10
    s_add_u32 s51, s51, s50
    s_mul_i32 s49, s49, 229376
    s_add_u32 s51, s51, s49
    s_mul_i32 s49, s38, s57
    s_add_u32 s51, s51, s49
    s_add_u32 s53, s51, 53477376
    s_lshl_b32 s48, s33, 2
    s_add_u32 s48, s48, 2
    s_mul_i32 s49, s48, 9363
    s_lshr_b32 s49, s49, 16
    s_mul_i32 s50, s49, 7
    s_sub_u32 s50, s48, s50
    s_cmp_lt_u32 s50, 4
    s_cselect_b32 s58, 4, 3
    s_cselect_b32 s51, 0, 126976
    s_lshl_b32 s58, s58, 10
    s_lshl_b32 s50, s50, 10
    s_add_u32 s51, s51, s50
    s_mul_i32 s49, s49, 229376
    s_add_u32 s51, s51, s49
    s_mul_i32 s49, s38, s58
    s_add_u32 s51, s51, s49
    s_add_u32 s54, s51, 53477376
    s_lshl_b32 s48, s33, 2
    s_add_u32 s48, s48, 3
    s_mul_i32 s49, s48, 9363
    s_lshr_b32 s49, s49, 16
    s_mov_b32 s41, s49
    s_mul_i32 s50, s49, 7
    s_sub_u32 s50, s48, s50
    s_cmp_lt_u32 s50, 4
    s_cselect_b32 s59, 4, 3
    s_cselect_b32 s51, 0, 126976
    s_lshl_b32 s59, s59, 10
    s_lshl_b32 s50, s50, 10
    s_add_u32 s51, s51, s50
    s_mul_i32 s49, s49, 229376
    s_add_u32 s51, s51, s49
    s_mul_i32 s49, s38, s59
    s_add_u32 s51, s51, s49
    s_add_u32 s55, s51, 53477376
    s_waitcnt vmcnt(0)
    ds_read_b64_tr_b16 v[16:17], v11 offset:0
    ds_read_b64_tr_b16 v[18:19], v11 offset:512
    ds_read_b64_tr_b16 v[20:21], v11 offset:32
    ds_read_b64_tr_b16 v[22:23], v11 offset:544
    ds_read_b64_tr_b16 v[24:25], v11 offset:64
    ds_read_b64_tr_b16 v[26:27], v11 offset:576
    ds_read_b64_tr_b16 v[28:29], v11 offset:96
    ds_read_b64_tr_b16 v[30:31], v11 offset:608
    ds_read_b64_tr_b16 v[32:33], v11 offset:2048
    ds_read_b64_tr_b16 v[34:35], v11 offset:2560
    ds_read_b64_tr_b16 v[36:37], v11 offset:2080
    ds_read_b64_tr_b16 v[38:39], v11 offset:2592
    ds_read_b64_tr_b16 v[40:41], v11 offset:2112
    ds_read_b64_tr_b16 v[42:43], v11 offset:2624
    ds_read_b64_tr_b16 v[44:45], v11 offset:2144
    ds_read_b64_tr_b16 v[46:47], v11 offset:2656
    s_waitcnt lgkmcnt(0)
    buffer_store_dwordx4 v[16:19], v8, s[12:15], s52 offen sc1
    buffer_store_dwordx4 v[20:23], v8, s[12:15], s53 offen sc1
    buffer_store_dwordx4 v[24:27], v8, s[12:15], s54 offen sc1
    buffer_store_dwordx4 v[28:31], v8, s[12:15], s55 offen sc1
    s_add_u32 s52, s52, s56
    buffer_store_dwordx4 v[32:35], v8, s[12:15], s52 offen sc1
    s_add_u32 s53, s53, s57
    buffer_store_dwordx4 v[36:39], v8, s[12:15], s53 offen sc1
    s_add_u32 s54, s54, s58
    buffer_store_dwordx4 v[40:43], v8, s[12:15], s54 offen sc1
    s_add_u32 s55, s55, s59
    buffer_store_dwordx4 v[44:47], v8, s[12:15], s55 offen sc1
    v_mov_b32 v48, 0
    v_mov_b32 v49, 0
    v_mov_b32 v50, 0
    v_mov_b32 v51, 0
    v_dot2_f32_bf16 v48, v16, v9, v48
    v_dot2_f32_bf16 v49, v20, v9, v49
    v_dot2_f32_bf16 v50, v24, v9, v50
    v_dot2_f32_bf16 v51, v28, v9, v51
    v_dot2_f32_bf16 v48, v17, v9, v48
    v_dot2_f32_bf16 v49, v21, v9, v49
    v_dot2_f32_bf16 v50, v25, v9, v50
    v_dot2_f32_bf16 v51, v29, v9, v51
    v_dot2_f32_bf16 v48, v18, v9, v48
    v_dot2_f32_bf16 v49, v22, v9, v49
    v_dot2_f32_bf16 v50, v26, v9, v50
    v_dot2_f32_bf16 v51, v30, v9, v51
    v_dot2_f32_bf16 v48, v19, v9, v48
    v_dot2_f32_bf16 v49, v23, v9, v49
    v_dot2_f32_bf16 v50, v27, v9, v50
    v_dot2_f32_bf16 v51, v31, v9, v51
    v_dot2_f32_bf16 v48, v32, v9, v48
    v_dot2_f32_bf16 v49, v36, v9, v49
    v_dot2_f32_bf16 v50, v40, v9, v50
    v_dot2_f32_bf16 v51, v44, v9, v51
    v_dot2_f32_bf16 v48, v33, v9, v48
    v_dot2_f32_bf16 v49, v37, v9, v49
    v_dot2_f32_bf16 v50, v41, v9, v50
    v_dot2_f32_bf16 v51, v45, v9, v51
    v_dot2_f32_bf16 v48, v34, v9, v48
    v_dot2_f32_bf16 v49, v38, v9, v49
    v_dot2_f32_bf16 v50, v42, v9, v50
    v_dot2_f32_bf16 v51, v46, v9, v51
    v_dot2_f32_bf16 v48, v35, v9, v48
    v_dot2_f32_bf16 v49, v39, v9, v49
    v_dot2_f32_bf16 v50, v43, v9, v50
    v_dot2_f32_bf16 v51, v47, v9, v51
    v_mov_b32 v14, v48
    s_nop 1
    v_permlane32_swap_b32 v14, v48
    v_add_f32 v48, v48, v14
    v_mov_b32 v14, v49
    s_nop 1
    v_permlane32_swap_b32 v14, v49
    v_add_f32 v49, v49, v14
    v_mov_b32 v14, v50
    s_nop 1
    v_permlane32_swap_b32 v14, v50
    v_add_f32 v50, v50, v14
    v_mov_b32 v14, v51
    s_nop 1
    v_permlane32_swap_b32 v14, v51
    v_add_f32 v51, v51, v14
    v_cmp_gt_u32 s[46:47], 32, v0
    s_nop 1
    v_cndmask_b32 v48, v49, v48, s[46:47]
    v_cndmask_b32 v50, v51, v50, s[46:47]
    s_lshl_b32 s39, s30, 9
    s_add_u32 s39, s39, 122880
    v_lshlrev_b32 v14, 2, v0
    v_add_u32 v15, s39, v14
    ds_write_b32 v15, v48 offset:32768
    ds_write_b32 v15, v50 offset:33024
    s_waitcnt lgkmcnt(0)
    v_mov_b32 v56, 161792
    v_mov_b32 v57, 1
    ds_add_u32 v56, v57
    s_cmp_ge_u32 s30, 2
    s_cbranch_scc1 mega_kernel_pb_gu_fin
    v_mov_b32 v56, 161792
    s_mov_b32 s49, 0x100000
ldsw1:
    ds_read_b32 v57, v56
    s_waitcnt lgkmcnt(0)
    v_readfirstlane_b32 s50, v57
    s_nop 0
    s_cmp_ge_u32 s50, 256
    s_cbranch_scc1 ldsd1
    s_sub_u32 s49, s49, 1
    s_cmp_lg_u32 s49, 0
    s_cbranch_scc1 ldsw1
ldsd1:
    s_lshl_b32 s39, s30, 8
    v_add_u32 v15, s39, v14
    v_add_u32 v13, 122880, v15
    ds_read_b32 v52, v13 offset:32768
    ds_read_b32 v53, v13 offset:33280
    ds_read_b32 v54, v13 offset:33792
    ds_read_b32 v55, v13 offset:34304
    s_waitcnt lgkmcnt(0)
    v_add_f32 v52, v52, v53
    v_add_f32 v54, v54, v55
    v_add_f32 v52, v52, v54
    s_mul_i32 s38, s32, 14336
    s_lshl_b32 s39, s33, 9
    s_add_u32 s38, s38, s39
    s_add_u32 s38, s38, 59834368
    buffer_store_dword v52, v15, s[12:15], s38 offen sc1
mega_kernel_pb_gu_fin:
    s_cmp_eq_u32 s40, s41
    s_cselect_b32 s41, 0x100, s41
    v_and_b32 v2, 15, v0
    v_lshlrev_b32 v2, 4, v2
    v_add_u32 v3, s41, v2
    v_add_u32 v2, s40, v2
    v_cmp_gt_u32 s[46:47], 16, v0
    s_nop 1
    v_cndmask_b32 v2, v3, v2, s[46:47]
    s_mov_b32 s57, 655360
    s_branch mega_kernel_p2a228
mega_kernel_p2a228:
    s_barrier
    s_waitcnt vmcnt(0)
    v_mov_b32 v56, 161796
    v_mov_b32 v57, 1
    ds_add_u32 v56, v57
    s_cmp_lg_u32 s19, 0
    s_cbranch_scc1 mega_kernel_p2s230
    v_mov_b32 v56, 161796
    s_mov_b32 s49, 0x100000
ldsw2:
    ds_read_b32 v57, v56
    s_waitcnt lgkmcnt(0)
    v_readfirstlane_b32 s50, v57
    s_nop 0
    s_cmp_ge_u32 s50, 256
    s_cbranch_scc1 ldsd2
    s_sub_u32 s49, s49, 1
    s_cmp_lg_u32 s49, 0
    s_cbranch_scc1 ldsw2
ldsd2:
    s_movk_i32 s41, 0x100
    v_cmp_gt_u32 s[42:43], s41, v2
    v_lshlrev_b32 v2, 7, v2
    v_mov_b32 v3, 1
    s_add_u32 s40, s17, s57
    s_mov_b32 exec_lo, s42
    s_mov_b32 exec_hi, 0
    buffer_atomic_add v3, v2, s[12:15], s40 offen sc1
    s_mov_b64 exec, -1
mega_kernel_p2s230:
    s_branch mega_kernel_p2pe25
mega_kernel_p2np26:
    s_waitcnt vmcnt(10)
    s_barrier
    s_waitcnt vmcnt(0)
    s_barrier
    s_cmp_lg_u32 s18, 0
    s_cbranch_scc1 mega_kernel_p2nw33
    s_cmp_ge_u32 s19, 2
    s_cbranch_scc1 mega_kernel_p2nw33
    s_lshl_b32 s40, s20, 3
    s_add_u32 s40, s40, s21
    s_lshl_b32 s40, s40, 7
    s_add_u32 s40, s40, 61440000
    v_mov_b32 v2, 0
    s_mov_b32 s49, 0x4000
mega_kernel_pl34:
    buffer_load_dword v28, v2, s[12:15], s40 offen sc1
    s_waitcnt vmcnt(0)
    v_readfirstlane_b32 s50, v28
    s_nop 0
    s_cmp_ge_u32 s50, 2
    s_cbranch_scc1 mega_kernel_pd35
    s_sleep 1
    s_sub_u32 s49, s49, 1
    s_cmp_lg_u32 s49, 0
    s_cbranch_scc1 mega_kernel_pl34
mega_kernel_pd35:
mega_kernel_p2nw33:
    s_barrier
mega_kernel_p2pe25:
    s_and_b32 s30, s19, 1
    s_cmp_ge_u32 s19, 2
    s_cbranch_scc1 mega_kernel_la40
    s_mul_i32 s52, s21, 65536
    s_lshl_b32 s53, s30, 13
    s_add_u32 s52, s52, s53
    s_add_u32 s52, s52, 52428800
    s_add_u32 m0, s53, 65536
    s_add_u32 s59, s52, 0
    buffer_load_dwordx4 v1, s[12:15], s59 offen offset:0 sc1 lds
    buffer_load_dwordx4 v1, s[12:15], s59 offen offset:1024 sc1 lds
    buffer_load_dwordx4 v1, s[12:15], s59 offen offset:2048 sc1 lds
    buffer_load_dwordx4 v1, s[12:15], s59 offen offset:3072 sc1 lds
    s_add_u32 m0, s53, 69632
    s_add_u32 s59, s52, 4096
    buffer_load_dwordx4 v1, s[12:15], s59 offen offset:0 sc1 lds
    buffer_load_dwordx4 v1, s[12:15], s59 offen offset:1024 sc1 lds
    buffer_load_dwordx4 v1, s[12:15], s59 offen offset:2048 sc1 lds
    buffer_load_dwordx4 v1, s[12:15], s59 offen offset:3072 sc1 lds
    s_add_u32 m0, s53, 81920
    s_add_u32 s59, s52, 16384
    buffer_load_dwordx4 v1, s[12:15], s59 offen offset:0 sc1 lds
    buffer_load_dwordx4 v1, s[12:15], s59 offen offset:1024 sc1 lds
    buffer_load_dwordx4 v1, s[12:15], s59 offen offset:2048 sc1 lds
    buffer_load_dwordx4 v1, s[12:15], s59 offen offset:3072 sc1 lds
    s_add_u32 m0, s53, 86016
    s_add_u32 s59, s52, 20480
    buffer_load_dwordx4 v1, s[12:15], s59 offen offset:0 sc1 lds
    buffer_load_dwordx4 v1, s[12:15], s59 offen offset:1024 sc1 lds
    buffer_load_dwordx4 v1, s[12:15], s59 offen offset:2048 sc1 lds
    buffer_load_dwordx4 v1, s[12:15], s59 offen offset:3072 sc1 lds
    s_add_u32 m0, s53, 98304
    s_add_u32 s59, s52, 32768
    buffer_load_dwordx4 v1, s[12:15], s59 offen offset:0 sc1 lds
    buffer_load_dwordx4 v1, s[12:15], s59 offen offset:1024 sc1 lds
    buffer_load_dwordx4 v1, s[12:15], s59 offen offset:2048 sc1 lds
    buffer_load_dwordx4 v1, s[12:15], s59 offen offset:3072 sc1 lds
    s_add_u32 m0, s53, 102400
    s_add_u32 s59, s52, 36864
    buffer_load_dwordx4 v1, s[12:15], s59 offen offset:0 sc1 lds
    buffer_load_dwordx4 v1, s[12:15], s59 offen offset:1024 sc1 lds
    buffer_load_dwordx4 v1, s[12:15], s59 offen offset:2048 sc1 lds
    buffer_load_dwordx4 v1, s[12:15], s59 offen offset:3072 sc1 lds
    s_add_u32 m0, s53, 114688
    s_add_u32 s59, s52, 49152
    buffer_load_dwordx4 v1, s[12:15], s59 offen offset:0 sc1 lds
    buffer_load_dwordx4 v1, s[12:15], s59 offen offset:1024 sc1 lds
    buffer_load_dwordx4 v1, s[12:15], s59 offen offset:2048 sc1 lds
    buffer_load_dwordx4 v1, s[12:15], s59 offen offset:3072 sc1 lds
    s_add_u32 m0, s53, 118784
    s_add_u32 s59, s52, 53248
    buffer_load_dwordx4 v1, s[12:15], s59 offen offset:0 sc1 lds
    buffer_load_dwordx4 v1, s[12:15], s59 offen offset:1024 sc1 lds
    buffer_load_dwordx4 v1, s[12:15], s59 offen offset:2048 sc1 lds
    buffer_load_dwordx4 v1, s[12:15], s59 offen offset:3072 sc1 lds
    s_waitcnt vmcnt(24)
    s_barrier
    s_waitcnt vmcnt(16)
    s_barrier
    s_waitcnt vmcnt(8)
    s_barrier
    s_waitcnt vmcnt(0)
    s_barrier
    s_cmp_lg_u32 s18, 0
    s_cbranch_scc1 mega_kernel_p4nw42
    s_lshl_b32 s40, s28, 4
    s_add_u32 s40, s40, s29
    s_lshl_b32 s40, s40, 7
    s_add_u32 s40, s40, 61472768
    s_mul_i32 s47, s29, 7
    s_add_u32 s48, s47, 6
    s_lshr_b32 s47, s47, 2
    s_lshr_b32 s48, s48, 2
    s_sub_u32 s48, s48, s47
    s_add_u32 s48, s48, 1
    s_lshl_b32 s48, s48, 2
    v_mov_b32 v2, 0
    s_mov_b32 s49, 0x4000
mega_kernel_pl43:
    buffer_load_dword v28, v2, s[12:15], s40 offen sc1
    s_waitcnt vmcnt(0)
    v_readfirstlane_b32 s50, v28
    s_nop 0
    s_cmp_ge_u32 s50, s48
    s_cbranch_scc1 mega_kernel_pd44
    s_sleep 1
    s_sub_u32 s49, s49, 1
    s_cmp_lg_u32 s49, 0
    s_cbranch_scc1 mega_kernel_pl43
mega_kernel_pd44:
mega_kernel_p4nw42:
    s_cmp_lg_u32 s18, 0
    s_cbranch_scc1 mega_kernel_p4nd45
    s_lshl_b32 s40, s20, 3
    s_add_u32 s40, s40, s21
    s_lshl_b32 s40, s40, 7
    s_add_u32 s40, s40, 61505536
    v_mov_b32 v2, 0
    s_mov_b32 s49, 0x4000
mega_kernel_pl46:
    buffer_load_dword v28, v2, s[12:15], s40 offen sc1
    s_waitcnt vmcnt(0)
    v_readfirstlane_b32 s50, v28
    s_nop 0
    s_cmp_ge_u32 s50, 7
    s_cbranch_scc1 mega_kernel_pd47
    s_sleep 1
    s_sub_u32 s49, s49, 1
    s_cmp_lg_u32 s49, 0
    s_cbranch_scc1 mega_kernel_pl46
mega_kernel_pd47:
mega_kernel_p4nd45:
    s_barrier
    s_branch mega_kernel_le41
mega_kernel_la40:
    s_lshl_b32 s54, s20, 1
    s_add_u32 s54, s54, s30
    s_mul_i32 s54, s54, 32768
    s_add_u32 s54, s54, 6291456
    s_add_u32 s54, s54, s16
    s_lshl_b32 s53, s30, 13
    s_lshl_b32 s40, s20, 3
    s_add_u32 s40, s40, s21
    s_lshl_b32 s40, s40, 7
    s_add_u32 s40, s40, s17
    s_add_u32 s40, s40, 32768
    v_mov_b32 v2, 0
    s_mov_b32 s49, 0x4000
mega_kernel_pl48:
    buffer_load_dword v28, v2, s[12:15], s40 offen sc1
    s_waitcnt vmcnt(0)
    v_readfirstlane_b32 s50, v28
    s_nop 0
    s_cmp_ge_u32 s50, 8
    s_cbranch_scc1 mega_kernel_pd49
    s_sleep 1
    s_sub_u32 s49, s49, 1
    s_cmp_lg_u32 s49, 0
    s_cbranch_scc1 mega_kernel_pl48
mega_kernel_pd49:
    s_add_u32 m0, s53, 0
    s_add_u32 s59, s54, 0
    buffer_load_dwordx4 v1, s[12:15], s59 offen offset:0 sc1 lds
    buffer_load_dwordx4 v1, s[12:15], s59 offen offset:1024 sc1 lds
    buffer_load_dwordx4 v1, s[12:15], s59 offen offset:2048 sc1 lds
    buffer_load_dwordx4 v1, s[12:15], s59 offen offset:3072 sc1 lds
    s_add_u32 m0, s53, 4096
    s_add_u32 s59, s54, 4096
    buffer_load_dwordx4 v1, s[12:15], s59 offen offset:0 sc1 lds
    buffer_load_dwordx4 v1, s[12:15], s59 offen offset:1024 sc1 lds
    buffer_load_dwordx4 v1, s[12:15], s59 offen offset:2048 sc1 lds
    buffer_load_dwordx4 v1, s[12:15], s59 offen offset:3072 sc1 lds
    s_add_u32 m0, s53, 16384
    s_add_u32 s59, s54, 8192
    buffer_load_dwordx4 v1, s[12:15], s59 offen offset:0 sc1 lds
    buffer_load_dwordx4 v1, s[12:15], s59 offen offset:1024 sc1 lds
    buffer_load_dwordx4 v1, s[12:15], s59 offen offset:2048 sc1 lds
    buffer_load_dwordx4 v1, s[12:15], s59 offen offset:3072 sc1 lds
    s_add_u32 m0, s53, 20480
    s_add_u32 s59, s54, 12288
    buffer_load_dwordx4 v1, s[12:15], s59 offen offset:0 sc1 lds
    buffer_load_dwordx4 v1, s[12:15], s59 offen offset:1024 sc1 lds
    buffer_load_dwordx4 v1, s[12:15], s59 offen offset:2048 sc1 lds
    buffer_load_dwordx4 v1, s[12:15], s59 offen offset:3072 sc1 lds
    s_waitcnt vmcnt(8)
    s_barrier
    s_add_u32 m0, s53, 32768
    s_add_u32 s59, s54, 16384
    buffer_load_dwordx4 v1, s[12:15], s59 offen offset:0 sc1 lds
    buffer_load_dwordx4 v1, s[12:15], s59 offen offset:1024 sc1 lds
    buffer_load_dwordx4 v1, s[12:15], s59 offen offset:2048 sc1 lds
    buffer_load_dwordx4 v1, s[12:15], s59 offen offset:3072 sc1 lds
    s_add_u32 m0, s53, 36864
    s_add_u32 s59, s54, 20480
    buffer_load_dwordx4 v1, s[12:15], s59 offen offset:0 sc1 lds
    buffer_load_dwordx4 v1, s[12:15], s59 offen offset:1024 sc1 lds
    buffer_load_dwordx4 v1, s[12:15], s59 offen offset:2048 sc1 lds
    buffer_load_dwordx4 v1, s[12:15], s59 offen offset:3072 sc1 lds
    s_add_u32 m0, s53, 49152
    s_add_u32 s59, s54, 24576
    buffer_load_dwordx4 v1, s[12:15], s59 offen offset:0 sc1 lds
    buffer_load_dwordx4 v1, s[12:15], s59 offen offset:1024 sc1 lds
    buffer_load_dwordx4 v1, s[12:15], s59 offen offset:2048 sc1 lds
    buffer_load_dwordx4 v1, s[12:15], s59 offen offset:3072 sc1 lds
    s_add_u32 m0, s53, 53248
    s_add_u32 s59, s54, 28672
    buffer_load_dwordx4 v1, s[12:15], s59 offen offset:0 sc1 lds
    buffer_load_dwordx4 v1, s[12:15], s59 offen offset:1024 sc1 lds
    buffer_load_dwordx4 v1, s[12:15], s59 offen offset:2048 sc1 lds
    buffer_load_dwordx4 v1, s[12:15], s59 offen offset:3072 sc1 lds
    s_waitcnt vmcnt(16)
    s_barrier
    s_waitcnt vmcnt(8)
    s_barrier
    s_waitcnt vmcnt(0)
    s_barrier
    s_barrier
mega_kernel_le41:
    s_and_b32 s30, s19, 1
    s_cmp_ge_u32 s19, 2
    s_cbranch_scc1 mega_kernel_la55
    s_mul_i32 s42, s29, 229376
    s_add_u32 s42, s42, 53477376
    s_lshl_b32 s43, s30, 13
    s_mul_i32 s44, s30, 6144
    s_mul_i32 s46, s29, 896
    s_add_u32 s46, s46, 59834368
    s_add_u32 s47, s46, 0
    buffer_load_dwordx4 v[8:11], v1, s[12:15], s47 offen sc1
    s_add_u32 s47, s46, 14336
    buffer_load_dwordx4 v[12:15], v1, s[12:15], s47 offen sc1
    s_add_u32 s47, s46, 28672
    buffer_load_dwordx4 v[16:19], v1, s[12:15], s47 offen sc1
    s_add_u32 s47, s46, 43008
    buffer_load_dwordx4 v[20:23], v1, s[12:15], s47 offen sc1
    s_add_u32 s47, s42, 0
    s_add_u32 s47, s47, s43
    s_add_u32 m0, s43, 65536
    s_nop 0
    buffer_load_dwordx4 v1, s[12:15], s47 offen offset:0 sc1 lds
    buffer_load_dwordx4 v1, s[12:15], s47 offen offset:1024 sc1 lds
    buffer_load_dwordx4 v1, s[12:15], s47 offen offset:2048 sc1 lds
    buffer_load_dwordx4 v1, s[12:15], s47 offen offset:3072 sc1 lds
    s_add_u32 m0, s43, 69632
    s_add_u32 s47, s47, 4096
    buffer_load_dwordx4 v1, s[12:15], s47 offen offset:0 sc1 lds
    buffer_load_dwordx4 v1, s[12:15], s47 offen offset:1024 sc1 lds
    buffer_load_dwordx4 v1, s[12:15], s47 offen offset:2048 sc1 lds
    buffer_load_dwordx4 v1, s[12:15], s47 offen offset:3072 sc1 lds
    s_add_u32 s47, s42, 16384
    s_add_u32 s47, s47, s43
    s_add_u32 m0, s43, 81920
    s_nop 0
    buffer_load_dwordx4 v1, s[12:15], s47 offen offset:0 sc1 lds
    buffer_load_dwordx4 v1, s[12:15], s47 offen offset:1024 sc1 lds
    buffer_load_dwordx4 v1, s[12:15], s47 offen offset:2048 sc1 lds
    buffer_load_dwordx4 v1, s[12:15], s47 offen offset:3072 sc1 lds
    s_add_u32 m0, s43, 86016
    s_add_u32 s47, s47, 4096
    buffer_load_dwordx4 v1, s[12:15], s47 offen offset:0 sc1 lds
    buffer_load_dwordx4 v1, s[12:15], s47 offen offset:1024 sc1 lds
    buffer_load_dwordx4 v1, s[12:15], s47 offen offset:2048 sc1 lds
    buffer_load_dwordx4 v1, s[12:15], s47 offen offset:3072 sc1 lds
    s_add_u32 s47, s42, 32768
    s_add_u32 s47, s47, s43
    s_add_u32 m0, s43, 98304
    s_nop 0
    buffer_load_dwordx4 v1, s[12:15], s47 offen offset:0 sc1 lds
    buffer_load_dwordx4 v1, s[12:15], s47 offen offset:1024 sc1 lds
    buffer_load_dwordx4 v1, s[12:15], s47 offen offset:2048 sc1 lds
    buffer_load_dwordx4 v1, s[12:15], s47 offen offset:3072 sc1 lds
    s_add_u32 m0, s43, 102400
    s_add_u32 s47, s47, 4096
    buffer_load_dwordx4 v1, s[12:15], s47 offen offset:0 sc1 lds
    buffer_load_dwordx4 v1, s[12:15], s47 offen offset:1024 sc1 lds
    buffer_load_dwordx4 v1, s[12:15], s47 offen offset:2048 sc1 lds
    buffer_load_dwordx4 v1, s[12:15], s47 offen offset:3072 sc1 lds
    s_add_u32 s47, s42, 49152
    s_add_u32 s47, s47, s43
    s_add_u32 m0, s43, 114688
    s_nop 0
    buffer_load_dwordx4 v1, s[12:15], s47 offen offset:0 sc1 lds
    buffer_load_dwordx4 v1, s[12:15], s47 offen offset:1024 sc1 lds
    buffer_load_dwordx4 v1, s[12:15], s47 offen offset:2048 sc1 lds
    buffer_load_dwordx4 v1, s[12:15], s47 offen offset:3072 sc1 lds
    s_add_u32 m0, s43, 118784
    s_add_u32 s47, s47, 4096
    buffer_load_dwordx4 v1, s[12:15], s47 offen offset:0 sc1 lds
    buffer_load_dwordx4 v1, s[12:15], s47 offen offset:1024 sc1 lds
    buffer_load_dwordx4 v1, s[12:15], s47 offen offset:2048 sc1 lds
    buffer_load_dwordx4 v1, s[12:15], s47 offen offset:3072 sc1 lds
    s_waitcnt vmcnt(32)
    v_add_f32 v8, v8, v12
    v_add_f32 v16, v16, v20
    v_add_f32 v8, v8, v16
    v_add_f32 v9, v9, v13
    v_add_f32 v17, v17, v21
    v_add_f32 v9, v9, v17
    v_add_f32 v10, v10, v14
    v_add_f32 v18, v18, v22
    v_add_f32 v10, v10, v18
    v_add_f32 v11, v11, v15
    v_add_f32 v19, v19, v23
    v_add_f32 v11, v11, v19
    v_lshlrev_b32 v2, 2, v1
    v_add_u32 v2, 147456, v2
    v_lshrrev_b32 v12, 16, v8
    v_and_b32 v13, 0xffff0000, v8
    v_sub_f32 v13, v8, v13
    v_and_b32 v14, 0xffff0000, v13
    v_or_b32 v12, v12, v14
    v_sub_f32 v13, v13, v14
    v_lshrrev_b32 v13, 16, v13
    v_mov_b32 v14, 0
    v_mov_b32 v15, 0
    ds_write_b128 v2, v[12:15] offset:0
    v_lshrrev_b32 v16, 16, v9
    v_and_b32 v17, 0xffff0000, v9
    v_sub_f32 v17, v9, v17
    v_and_b32 v18, 0xffff0000, v17
    v_or_b32 v16, v16, v18
    v_sub_f32 v17, v17, v18
    v_lshrrev_b32 v17, 16, v17
    v_mov_b32 v18, 0
    v_mov_b32 v19, 0
    ds_write_b128 v2, v[16:19] offset:16
    v_lshrrev_b32 v20, 16, v10
    v_and_b32 v21, 0xffff0000, v10
    v_sub_f32 v21, v10, v21
    v_and_b32 v22, 0xffff0000, v21
    v_or_b32 v20, v20, v22
    v_sub_f32 v21, v21, v22
    v_lshrrev_b32 v21, 16, v21
    v_mov_b32 v22, 0
    v_mov_b32 v23, 0
    ds_write_b128 v2, v[20:23] offset:32
    v_lshrrev_b32 v24, 16, v11
    v_and_b32 v25, 0xffff0000, v11
    v_sub_f32 v25, v11, v25
    v_and_b32 v26, 0xffff0000, v25
    v_or_b32 v24, v24, v26
    v_sub_f32 v25, v25, v26
    v_lshrrev_b32 v25, 16, v25
    v_mov_b32 v26, 0
    v_mov_b32 v27, 0
    ds_write_b128 v2, v[24:27] offset:48
    s_waitcnt lgkmcnt(0)
    s_waitcnt vmcnt(24)
    s_barrier
    s_waitcnt vmcnt(16)
    s_barrier
    s_waitcnt vmcnt(8)
    s_barrier
    s_add_u32 s47, s42, 65536
    s_add_u32 s47, s47, s43
    s_add_u32 m0, s43, 65536
    s_nop 0
    buffer_load_dwordx4 v1, s[12:15], s47 offen offset:0 sc1 lds
    buffer_load_dwordx4 v1, s[12:15], s47 offen offset:1024 sc1 lds
    buffer_load_dwordx4 v1, s[12:15], s47 offen offset:2048 sc1 lds
    buffer_load_dwordx4 v1, s[12:15], s47 offen offset:3072 sc1 lds
    s_add_u32 m0, s43, 69632
    s_add_u32 s47, s47, 4096
    buffer_load_dwordx4 v1, s[12:15], s47 offen offset:0 sc1 lds
    buffer_load_dwordx4 v1, s[12:15], s47 offen offset:1024 sc1 lds
    buffer_load_dwordx4 v1, s[12:15], s47 offen offset:2048 sc1 lds
    buffer_load_dwordx4 v1, s[12:15], s47 offen offset:3072 sc1 lds
    s_waitcnt vmcnt(8)
    s_barrier
    s_add_u32 s47, s42, 81920
    s_add_u32 s47, s47, s43
    s_add_u32 m0, s43, 81920
    s_nop 0
    buffer_load_dwordx4 v1, s[12:15], s47 offen offset:0 sc1 lds
    buffer_load_dwordx4 v1, s[12:15], s47 offen offset:1024 sc1 lds
    buffer_load_dwordx4 v1, s[12:15], s47 offen offset:2048 sc1 lds
    buffer_load_dwordx4 v1, s[12:15], s47 offen offset:3072 sc1 lds
    s_add_u32 m0, s43, 86016
    s_add_u32 s47, s47, 4096
    buffer_load_dwordx4 v1, s[12:15], s47 offen offset:0 sc1 lds
    buffer_load_dwordx4 v1, s[12:15], s47 offen offset:1024 sc1 lds
    buffer_load_dwordx4 v1, s[12:15], s47 offen offset:2048 sc1 lds
    buffer_load_dwordx4 v1, s[12:15], s47 offen offset:3072 sc1 lds
    s_waitcnt vmcnt(8)
    s_barrier
    s_add_u32 s47, s42, 98304
    s_add_u32 s47, s47, s43
    s_add_u32 m0, s43, 98304
    s_nop 0
    buffer_load_dwordx4 v1, s[12:15], s47 offen offset:0 sc1 lds
    buffer_load_dwordx4 v1, s[12:15], s47 offen offset:1024 sc1 lds
    buffer_load_dwordx4 v1, s[12:15], s47 offen offset:2048 sc1 lds
    buffer_load_dwordx4 v1, s[12:15], s47 offen offset:3072 sc1 lds
    s_add_u32 m0, s43, 102400
    s_add_u32 s47, s47, 4096
    buffer_load_dwordx4 v1, s[12:15], s47 offen offset:0 sc1 lds
    buffer_load_dwordx4 v1, s[12:15], s47 offen offset:1024 sc1 lds
    buffer_load_dwordx4 v1, s[12:15], s47 offen offset:2048 sc1 lds
    buffer_load_dwordx4 v1, s[12:15], s47 offen offset:3072 sc1 lds
    s_waitcnt vmcnt(8)
    s_barrier
    s_add_u32 s47, s42, 114688
    s_add_u32 s47, s47, s43
    s_add_u32 m0, s43, 114688
    s_nop 0
    buffer_load_dwordx4 v1, s[12:15], s47 offen offset:0 sc1 lds
    buffer_load_dwordx4 v1, s[12:15], s47 offen offset:1024 sc1 lds
    buffer_load_dwordx4 v1, s[12:15], s47 offen offset:2048 sc1 lds
    buffer_load_dwordx4 v1, s[12:15], s47 offen offset:3072 sc1 lds
    s_add_u32 m0, s43, 118784
    s_add_u32 s47, s47, 4096
    buffer_load_dwordx4 v1, s[12:15], s47 offen offset:0 sc1 lds
    buffer_load_dwordx4 v1, s[12:15], s47 offen offset:1024 sc1 lds
    buffer_load_dwordx4 v1, s[12:15], s47 offen offset:2048 sc1 lds
    buffer_load_dwordx4 v1, s[12:15], s47 offen offset:3072 sc1 lds
    s_add_u32 s47, s42, 180224
    s_add_u32 s47, s47, s44
    s_add_u32 m0, s44, 65536
    s_nop 0
    buffer_load_dwordx4 v1, s[12:15], s47 offen offset:0 sc1 lds
    buffer_load_dwordx4 v1, s[12:15], s47 offen offset:1024 sc1 lds
    buffer_load_dwordx4 v1, s[12:15], s47 offen offset:2048 sc1 lds
    s_add_u32 m0, s44, 68608
    s_add_u32 s47, s47, 3072
    buffer_load_dwordx4 v1, s[12:15], s47 offen offset:0 sc1 lds
    buffer_load_dwordx4 v1, s[12:15], s47 offen offset:1024 sc1 lds
    buffer_load_dwordx4 v1, s[12:15], s47 offen offset:2048 sc1 lds
    s_waitcnt vmcnt(14)
    s_barrier
    s_add_u32 s47, s42, 192512
    s_add_u32 s47, s47, s44
    s_add_u32 m0, s44, 81920
    s_nop 0
    buffer_load_dwordx4 v1, s[12:15], s47 offen offset:0 sc1 lds
    buffer_load_dwordx4 v1, s[12:15], s47 offen offset:1024 sc1 lds
    buffer_load_dwordx4 v1, s[12:15], s47 offen offset:2048 sc1 lds
    s_add_u32 m0, s44, 84992
    s_add_u32 s47, s47, 3072
    buffer_load_dwordx4 v1, s[12:15], s47 offen offset:0 sc1 lds
    buffer_load_dwordx4 v1, s[12:15], s47 offen offset:1024 sc1 lds
    buffer_load_dwordx4 v1, s[12:15], s47 offen offset:2048 sc1 lds
    s_waitcnt vmcnt(12)
    s_barrier
    s_add_u32 s47, s42, 204800
    s_add_u32 s47, s47, s44
    s_add_u32 m0, s44, 98304
    s_nop 0
    buffer_load_dwordx4 v1, s[12:15], s47 offen offset:0 sc1 lds
    buffer_load_dwordx4 v1, s[12:15], s47 offen offset:1024 sc1 lds
    buffer_load_dwordx4 v1, s[12:15], s47 offen offset:2048 sc1 lds
    s_add_u32 m0, s44, 101376
    s_add_u32 s47, s47, 3072
    buffer_load_dwordx4 v1, s[12:15], s47 offen offset:0 sc1 lds
    buffer_load_dwordx4 v1, s[12:15], s47 offen offset:1024 sc1 lds
    buffer_load_dwordx4 v1, s[12:15], s47 offen offset:2048 sc1 lds
    s_waitcnt vmcnt(12)
    s_barrier
    s_add_u32 s47, s42, 217088
    s_add_u32 s47, s47, s44
    s_add_u32 m0, s44, 114688
    s_nop 0
    buffer_load_dwordx4 v1, s[12:15], s47 offen offset:0 sc1 lds
    buffer_load_dwordx4 v1, s[12:15], s47 offen offset:1024 sc1 lds
    buffer_load_dwordx4 v1, s[12:15], s47 offen offset:2048 sc1 lds
    s_add_u32 m0, s44, 117760
    s_add_u32 s47, s47, 3072
    buffer_load_dwordx4 v1, s[12:15], s47 offen offset:0 sc1 lds
    buffer_load_dwordx4 v1, s[12:15], s47 offen offset:1024 sc1 lds
    buffer_load_dwordx4 v1, s[12:15], s47 offen offset:2048 sc1 lds
    s_waitcnt vmcnt(12)
    s_barrier
    s_add_u32 s47, s42, 131072
    s_add_u32 s47, s47, s44
    s_add_u32 m0, s44, 65536
    s_nop 0
    buffer_load_dwordx4 v1, s[12:15], s47 offen offset:0 sc1 lds
    buffer_load_dwordx4 v1, s[12:15], s47 offen offset:1024 sc1 lds
    buffer_load_dwordx4 v1, s[12:15], s47 offen offset:2048 sc1 lds
    s_add_u32 m0, s44, 68608
    s_add_u32 s47, s47, 3072
    buffer_load_dwordx4 v1, s[12:15], s47 offen offset:0 sc1 lds
    buffer_load_dwordx4 v1, s[12:15], s47 offen offset:1024 sc1 lds
    buffer_load_dwordx4 v1, s[12:15], s47 offen offset:2048 sc1 lds
    s_waitcnt vmcnt(12)
    s_barrier
    s_add_u32 s47, s42, 143360
    s_add_u32 s47, s47, s44
    s_add_u32 m0, s44, 81920
    s_nop 0
    buffer_load_dwordx4 v1, s[12:15], s47 offen offset:0 sc1 lds
    buffer_load_dwordx4 v1, s[12:15], s47 offen offset:1024 sc1 lds
    buffer_load_dwordx4 v1, s[12:15], s47 offen offset:2048 sc1 lds
    s_add_u32 m0, s44, 84992
    s_add_u32 s47, s47, 3072
    buffer_load_dwordx4 v1, s[12:15], s47 offen offset:0 sc1 lds
    buffer_load_dwordx4 v1, s[12:15], s47 offen offset:1024 sc1 lds
    buffer_load_dwordx4 v1, s[12:15], s47 offen offset:2048 sc1 lds
    s_waitcnt vmcnt(12)
    s_barrier
    s_add_u32 s47, s42, 155648
    s_add_u32 s47, s47, s44
    s_add_u32 m0, s44, 98304
    s_nop 0
    buffer_load_dwordx4 v1, s[12:15], s47 offen offset:0 sc1 lds
    buffer_load_dwordx4 v1, s[12:15], s47 offen offset:1024 sc1 lds
    buffer_load_dwordx4 v1, s[12:15], s47 offen offset:2048 sc1 lds
    s_add_u32 m0, s44, 101376
    s_add_u32 s47, s47, 3072
    buffer_load_dwordx4 v1, s[12:15], s47 offen offset:0 sc1 lds
    buffer_load_dwordx4 v1, s[12:15], s47 offen offset:1024 sc1 lds
    buffer_load_dwordx4 v1, s[12:15], s47 offen offset:2048 sc1 lds
    s_waitcnt vmcnt(12)
    s_barrier
    s_add_u32 s47, s42, 167936
    s_add_u32 s47, s47, s44
    s_add_u32 m0, s44, 114688
    s_nop 0
    buffer_load_dwordx4 v1, s[12:15], s47 offen offset:0 sc1 lds
    buffer_load_dwordx4 v1, s[12:15], s47 offen offset:1024 sc1 lds
    buffer_load_dwordx4 v1, s[12:15], s47 offen offset:2048 sc1 lds
    s_add_u32 m0, s44, 117760
    s_add_u32 s47, s47, 3072
    buffer_load_dwordx4 v1, s[12:15], s47 offen offset:0 sc1 lds
    buffer_load_dwordx4 v1, s[12:15], s47 offen offset:1024 sc1 lds
    buffer_load_dwordx4 v1, s[12:15], s47 offen offset:2048 sc1 lds
    s_waitcnt vmcnt(12)
    s_barrier
    s_mul_i32 s52, s21, 229376
    s_lshl_b32 s53, s30, 13
    s_add_u32 s52, s52, s53
    s_add_u32 s52, s52, 57671680
    s_add_u32 m0, s53, 65536
    s_add_u32 s59, s52, 0
    buffer_load_dwordx4 v1, s[12:15], s59 offen offset:0 sc1 lds
    buffer_load_dwordx4 v1, s[12:15], s59 offen offset:1024 sc1 lds
    buffer_load_dwordx4 v1, s[12:15], s59 offen offset:2048 sc1 lds
    buffer_load_dwordx4 v1, s[12:15], s59 offen offset:3072 sc1 lds
    s_add_u32 m0, s53, 69632
    s_add_u32 s59, s52, 4096
    buffer_load_dwordx4 v1, s[12:15], s59 offen offset:0 sc1 lds
    buffer_load_dwordx4 v1, s[12:15], s59 offen offset:1024 sc1 lds
    buffer_load_dwordx4 v1, s[12:15], s59 offen offset:2048 sc1 lds
    buffer_load_dwordx4 v1, s[12:15], s59 offen offset:3072 sc1 lds
    s_waitcnt vmcnt(14)
    s_barrier
    s_add_u32 m0, s53, 81920
    s_add_u32 s59, s52, 16384
    buffer_load_dwordx4 v1, s[12:15], s59 offen offset:0 sc1 lds
    buffer_load_dwordx4 v1, s[12:15], s59 offen offset:1024 sc1 lds
    buffer_load_dwordx4 v1, s[12:15], s59 offen offset:2048 sc1 lds
    buffer_load_dwordx4 v1, s[12:15], s59 offen offset:3072 sc1 lds
    s_add_u32 m0, s53, 86016
    s_add_u32 s59, s52, 20480
    buffer_load_dwordx4 v1, s[12:15], s59 offen offset:0 sc1 lds
    buffer_load_dwordx4 v1, s[12:15], s59 offen offset:1024 sc1 lds
    buffer_load_dwordx4 v1, s[12:15], s59 offen offset:2048 sc1 lds
    buffer_load_dwordx4 v1, s[12:15], s59 offen offset:3072 sc1 lds
    s_waitcnt vmcnt(16)
    s_barrier
    s_add_u32 m0, s53, 98304
    s_add_u32 s59, s52, 32768
    buffer_load_dwordx4 v1, s[12:15], s59 offen offset:0 sc1 lds
    buffer_load_dwordx4 v1, s[12:15], s59 offen offset:1024 sc1 lds
    buffer_load_dwordx4 v1, s[12:15], s59 offen offset:2048 sc1 lds
    buffer_load_dwordx4 v1, s[12:15], s59 offen offset:3072 sc1 lds
    s_add_u32 m0, s53, 102400
    s_add_u32 s59, s52, 36864
    buffer_load_dwordx4 v1, s[12:15], s59 offen offset:0 sc1 lds
    buffer_load_dwordx4 v1, s[12:15], s59 offen offset:1024 sc1 lds
    buffer_load_dwordx4 v1, s[12:15], s59 offen offset:2048 sc1 lds
    buffer_load_dwordx4 v1, s[12:15], s59 offen offset:3072 sc1 lds
    s_barrier
    s_branch mega_kernel_le56
mega_kernel_la55:
    s_lshl_b32 s43, s30, 13
    s_lshl_b32 s44, s28, 2
    s_lshl_b32 s45, s30, 1
    s_add_u32 s44, s44, s45
    s_lshl_b32 s45, s44, 12
    s_add_u32 s45, s45, 22020096
    s_add_u32 s45, s45, s16
    s_lshl_b32 s44, s44, 15
    s_add_u32 s44, s44, 8388608
    s_add_u32 s44, s44, s16
    s_lshl_b32 s40, s28, 4
    s_add_u32 s40, s40, s29
    s_lshl_b32 s40, s40, 7
    s_add_u32 s40, s40, s17
    s_add_u32 s40, s40, 65536
    v_mov_b32 v2, 0
    s_mov_b32 s49, 0x4000
mega_kernel_pl57:
    buffer_load_dword v28, v2, s[12:15], s40 offen sc1
    s_waitcnt vmcnt(0)
    v_readfirstlane_b32 s50, v28
    s_nop 0
    s_cmp_ge_u32 s50, 16
    s_cbranch_scc1 mega_kernel_pd58
    s_sleep 1
    s_sub_u32 s49, s49, 1
    s_cmp_lg_u32 s49, 0
    s_cbranch_scc1 mega_kernel_pl57
mega_kernel_pd58:
    s_add_u32 m0, s43, 0
    s_add_u32 s47, s44, 0
    buffer_load_dwordx4 v1, s[12:15], s47 offen offset:0 sc1 lds
    buffer_load_dwordx4 v1, s[12:15], s47 offen offset:1024 sc1 lds
    buffer_load_dwordx4 v1, s[12:15], s47 offen offset:2048 sc1 lds
    buffer_load_dwordx4 v1, s[12:15], s47 offen offset:3072 sc1 lds
    s_add_u32 m0, s43, 4096
    s_add_u32 s47, s44, 32768
    buffer_load_dwordx4 v1, s[12:15], s47 offen offset:0 sc1 lds
    buffer_load_dwordx4 v1, s[12:15], s47 offen offset:1024 sc1 lds
    buffer_load_dwordx4 v1, s[12:15], s47 offen offset:2048 sc1 lds
    buffer_load_dwordx4 v1, s[12:15], s47 offen offset:3072 sc1 lds
    s_add_u32 m0, s43, 16384
    s_add_u32 s47, s44, 4096
    buffer_load_dwordx4 v1, s[12:15], s47 offen offset:0 sc1 lds
    buffer_load_dwordx4 v1, s[12:15], s47 offen offset:1024 sc1 lds
    buffer_load_dwordx4 v1, s[12:15], s47 offen offset:2048 sc1 lds
    buffer_load_dwordx4 v1, s[12:15], s47 offen offset:3072 sc1 lds
    s_add_u32 m0, s43, 20480
    s_add_u32 s47, s44, 36864
    buffer_load_dwordx4 v1, s[12:15], s47 offen offset:0 sc1 lds
    buffer_load_dwordx4 v1, s[12:15], s47 offen offset:1024 sc1 lds
    buffer_load_dwordx4 v1, s[12:15], s47 offen offset:2048 sc1 lds
    buffer_load_dwordx4 v1, s[12:15], s47 offen offset:3072 sc1 lds
    s_add_u32 m0, s43, 131072
    s_add_u32 s47, s45, 0
    buffer_load_dwordx4 v1, s[12:15], s47 offen offset:0 sc1 lds
    buffer_load_dwordx4 v1, s[12:15], s47 offen offset:1024 sc1 lds
    buffer_load_dwordx4 v1, s[12:15], s47 offen offset:2048 sc1 lds
    buffer_load_dwordx4 v1, s[12:15], s47 offen offset:3072 sc1 lds
    s_add_u32 m0, s43, 135168
    s_add_u32 s47, s45, 4096
    buffer_load_dwordx4 v1, s[12:15], s47 offen offset:0 sc1 lds
    buffer_load_dwordx4 v1, s[12:15], s47 offen offset:1024 sc1 lds
    buffer_load_dwordx4 v1, s[12:15], s47 offen offset:2048 sc1 lds
    buffer_load_dwordx4 v1, s[12:15], s47 offen offset:3072 sc1 lds
    s_waitcnt vmcnt(16)
    s_barrier
    s_add_u32 m0, s43, 32768
    s_add_u32 s47, s44, 8192
    buffer_load_dwordx4 v1, s[12:15], s47 offen offset:0 sc1 lds
    buffer_load_dwordx4 v1, s[12:15], s47 offen offset:1024 sc1 lds
    buffer_load_dwordx4 v1, s[12:15], s47 offen offset:2048 sc1 lds
    buffer_load_dwordx4 v1, s[12:15], s47 offen offset:3072 sc1 lds
    s_add_u32 m0, s43, 36864
    s_add_u32 s47, s44, 40960
    buffer_load_dwordx4 v1, s[12:15], s47 offen offset:0 sc1 lds
    buffer_load_dwordx4 v1, s[12:15], s47 offen offset:1024 sc1 lds
    buffer_load_dwordx4 v1, s[12:15], s47 offen offset:2048 sc1 lds
    buffer_load_dwordx4 v1, s[12:15], s47 offen offset:3072 sc1 lds
    s_add_u32 m0, s43, 49152
    s_add_u32 s47, s44, 12288
    buffer_load_dwordx4 v1, s[12:15], s47 offen offset:0 sc1 lds
    buffer_load_dwordx4 v1, s[12:15], s47 offen offset:1024 sc1 lds
    buffer_load_dwordx4 v1, s[12:15], s47 offen offset:2048 sc1 lds
    buffer_load_dwordx4 v1, s[12:15], s47 offen offset:3072 sc1 lds
    s_add_u32 m0, s43, 53248
    s_add_u32 s47, s44, 45056
    buffer_load_dwordx4 v1, s[12:15], s47 offen offset:0 sc1 lds
    buffer_load_dwordx4 v1, s[12:15], s47 offen offset:1024 sc1 lds
    buffer_load_dwordx4 v1, s[12:15], s47 offen offset:2048 sc1 lds
    buffer_load_dwordx4 v1, s[12:15], s47 offen offset:3072 sc1 lds
    s_waitcnt vmcnt(16)
    s_barrier
    s_waitcnt vmcnt(8)
    s_barrier
    s_add_u32 m0, s43, 0
    s_add_u32 s47, s44, 16384
    buffer_load_dwordx4 v1, s[12:15], s47 offen offset:0 sc1 lds
    buffer_load_dwordx4 v1, s[12:15], s47 offen offset:1024 sc1 lds
    buffer_load_dwordx4 v1, s[12:15], s47 offen offset:2048 sc1 lds
    buffer_load_dwordx4 v1, s[12:15], s47 offen offset:3072 sc1 lds
    s_add_u32 m0, s43, 4096
    s_add_u32 s47, s44, 49152
    buffer_load_dwordx4 v1, s[12:15], s47 offen offset:0 sc1 lds
    buffer_load_dwordx4 v1, s[12:15], s47 offen offset:1024 sc1 lds
    buffer_load_dwordx4 v1, s[12:15], s47 offen offset:2048 sc1 lds
    buffer_load_dwordx4 v1, s[12:15], s47 offen offset:3072 sc1 lds
    s_waitcnt vmcnt(8)
    s_barrier
    s_add_u32 m0, s43, 16384
    s_add_u32 s47, s44, 20480
    buffer_load_dwordx4 v1, s[12:15], s47 offen offset:0 sc1 lds
    buffer_load_dwordx4 v1, s[12:15], s47 offen offset:1024 sc1 lds
    buffer_load_dwordx4 v1, s[12:15], s47 offen offset:2048 sc1 lds
    buffer_load_dwordx4 v1, s[12:15], s47 offen offset:3072 sc1 lds
    s_add_u32 m0, s43, 20480
    s_add_u32 s47, s44, 53248
    buffer_load_dwordx4 v1, s[12:15], s47 offen offset:0 sc1 lds
    buffer_load_dwordx4 v1, s[12:15], s47 offen offset:1024 sc1 lds
    buffer_load_dwordx4 v1, s[12:15], s47 offen offset:2048 sc1 lds
    buffer_load_dwordx4 v1, s[12:15], s47 offen offset:3072 sc1 lds
    s_waitcnt vmcnt(8)
    s_barrier
    s_add_u32 m0, s43, 32768
    s_add_u32 s47, s44, 24576
    buffer_load_dwordx4 v1, s[12:15], s47 offen offset:0 sc1 lds
    buffer_load_dwordx4 v1, s[12:15], s47 offen offset:1024 sc1 lds
    buffer_load_dwordx4 v1, s[12:15], s47 offen offset:2048 sc1 lds
    buffer_load_dwordx4 v1, s[12:15], s47 offen offset:3072 sc1 lds
    s_add_u32 m0, s43, 36864
    s_add_u32 s47, s44, 57344
    buffer_load_dwordx4 v1, s[12:15], s47 offen offset:0 sc1 lds
    buffer_load_dwordx4 v1, s[12:15], s47 offen offset:1024 sc1 lds
    buffer_load_dwordx4 v1, s[12:15], s47 offen offset:2048 sc1 lds
    buffer_load_dwordx4 v1, s[12:15], s47 offen offset:3072 sc1 lds
    s_waitcnt vmcnt(8)
    s_barrier
    s_add_u32 m0, s43, 49152
    s_add_u32 s47, s44, 28672
    buffer_load_dwordx4 v1, s[12:15], s47 offen offset:0 sc1 lds
    buffer_load_dwordx4 v1, s[12:15], s47 offen offset:1024 sc1 lds
    buffer_load_dwordx4 v1, s[12:15], s47 offen offset:2048 sc1 lds
    buffer_load_dwordx4 v1, s[12:15], s47 offen offset:3072 sc1 lds
    s_add_u32 m0, s43, 53248
    s_add_u32 s47, s44, 61440
    buffer_load_dwordx4 v1, s[12:15], s47 offen offset:0 sc1 lds
    buffer_load_dwordx4 v1, s[12:15], s47 offen offset:1024 sc1 lds
    buffer_load_dwordx4 v1, s[12:15], s47 offen offset:2048 sc1 lds
    buffer_load_dwordx4 v1, s[12:15], s47 offen offset:3072 sc1 lds
    s_waitcnt vmcnt(8)
    s_barrier
    s_waitcnt vmcnt(0)
    s_barrier
    s_waitcnt vmcnt(0)
    s_barrier
    s_waitcnt vmcnt(0)
    s_barrier
    s_add_u32 m0, s43, 0
    s_add_u32 s47, s44, 0
    buffer_load_dwordx4 v1, s[12:15], s47 offen offset:0 sc1 lds
    buffer_load_dwordx4 v1, s[12:15], s47 offen offset:1024 sc1 lds
    buffer_load_dwordx4 v1, s[12:15], s47 offen offset:2048 sc1 lds
    buffer_load_dwordx4 v1, s[12:15], s47 offen offset:3072 sc1 lds
    s_add_u32 m0, s43, 4096
    s_add_u32 s47, s44, 32768
    buffer_load_dwordx4 v1, s[12:15], s47 offen offset:0 sc1 lds
    buffer_load_dwordx4 v1, s[12:15], s47 offen offset:1024 sc1 lds
    buffer_load_dwordx4 v1, s[12:15], s47 offen offset:2048 sc1 lds
    buffer_load_dwordx4 v1, s[12:15], s47 offen offset:3072 sc1 lds
    s_waitcnt vmcnt(8)
    s_barrier
    s_add_u32 m0, s43, 16384
    s_add_u32 s47, s44, 4096
    buffer_load_dwordx4 v1, s[12:15], s47 offen offset:0 sc1 lds
    buffer_load_dwordx4 v1, s[12:15], s47 offen offset:1024 sc1 lds
    buffer_load_dwordx4 v1, s[12:15], s47 offen offset:2048 sc1 lds
    buffer_load_dwordx4 v1, s[12:15], s47 offen offset:3072 sc1 lds
    s_add_u32 m0, s43, 20480
    s_add_u32 s47, s44, 36864
    buffer_load_dwordx4 v1, s[12:15], s47 offen offset:0 sc1 lds
    buffer_load_dwordx4 v1, s[12:15], s47 offen offset:1024 sc1 lds
    buffer_load_dwordx4 v1, s[12:15], s47 offen offset:2048 sc1 lds
    buffer_load_dwordx4 v1, s[12:15], s47 offen offset:3072 sc1 lds
    s_waitcnt vmcnt(16)
    s_barrier
    s_add_u32 m0, s43, 32768
    s_add_u32 s47, s44, 8192
    buffer_load_dwordx4 v1, s[12:15], s47 offen offset:0 sc1 lds
    buffer_load_dwordx4 v1, s[12:15], s47 offen offset:1024 sc1 lds
    buffer_load_dwordx4 v1, s[12:15], s47 offen offset:2048 sc1 lds
    buffer_load_dwordx4 v1, s[12:15], s47 offen offset:3072 sc1 lds
    s_add_u32 m0, s43, 36864
    s_add_u32 s47, s44, 40960
    buffer_load_dwordx4 v1, s[12:15], s47 offen offset:0 sc1 lds
    buffer_load_dwordx4 v1, s[12:15], s47 offen offset:1024 sc1 lds
    buffer_load_dwordx4 v1, s[12:15], s47 offen offset:2048 sc1 lds
    buffer_load_dwordx4 v1, s[12:15], s47 offen offset:3072 sc1 lds
    s_waitcnt vmcnt(16)
    s_barrier
    s_add_u32 m0, s43, 49152
    s_add_u32 s47, s44, 12288
    buffer_load_dwordx4 v1, s[12:15], s47 offen offset:0 sc1 lds
    buffer_load_dwordx4 v1, s[12:15], s47 offen offset:1024 sc1 lds
    buffer_load_dwordx4 v1, s[12:15], s47 offen offset:2048 sc1 lds
    buffer_load_dwordx4 v1, s[12:15], s47 offen offset:3072 sc1 lds
    s_add_u32 m0, s43, 53248
    s_add_u32 s47, s44, 45056
    buffer_load_dwordx4 v1, s[12:15], s47 offen offset:0 sc1 lds
    buffer_load_dwordx4 v1, s[12:15], s47 offen offset:1024 sc1 lds
    buffer_load_dwordx4 v1, s[12:15], s47 offen offset:2048 sc1 lds
    buffer_load_dwordx4 v1, s[12:15], s47 offen offset:3072 sc1 lds
    s_waitcnt vmcnt(16)
    s_barrier
    s_waitcnt vmcnt(8)
    s_barrier
    s_waitcnt vmcnt(0)
    s_barrier
    s_lshl_b32 s54, s20, 1
    s_add_u32 s54, s54, s30
    s_mul_i32 s54, s54, 114688
    s_add_u32 s54, s54, 10485760
    s_add_u32 s54, s54, s16
    s_lshl_b32 s53, s30, 13
    s_lshl_b32 s40, s20, 3
    s_add_u32 s40, s40, s21
    s_lshl_b32 s40, s40, 7
    s_add_u32 s40, s40, s17
    s_add_u32 s40, s40, 98304
    v_mov_b32 v2, 0
    v_mov_b32 v4, 151552
    s_mov_b32 s49, 0x8000
mega_kernel_t5p61:
    buffer_load_dword v3, v2, s[12:15], s40 offen sc1
    s_waitcnt vmcnt(0)
    ds_read_b32 v5, v4
    v_readfirstlane_b32 s50, v3
    s_nop 0
    s_cmp_ge_u32 s50, 16
    s_cbranch_scc1 mega_kernel_t5g60
    s_waitcnt lgkmcnt(0)
    v_readfirstlane_b32 s50, v5
    s_nop 0
    s_cmp_lg_u32 s50, 0
    s_cbranch_scc1 mega_kernel_t5l59
    s_sub_u32 s49, s49, 1
    s_cmp_lg_u32 s49, 0
    s_cbranch_scc1 mega_kernel_t5p61
mega_kernel_t5l59:
    s_barrier
    v_mov_b32 v2, 0
    s_mov_b32 s49, 0x4000
mega_kernel_pl63:
    buffer_load_dword v28, v2, s[12:15], s40 offen sc1
    s_waitcnt vmcnt(0)
    v_readfirstlane_b32 s50, v28
    s_nop 0
    s_cmp_ge_u32 s50, 16
    s_cbranch_scc1 mega_kernel_pd64
    s_sleep 1
    s_sub_u32 s49, s49, 1
    s_cmp_lg_u32 s49, 0
    s_cbranch_scc1 mega_kernel_pl63
mega_kernel_pd64:
    s_add_u32 m0, s53, 0
    s_add_u32 s59, s54, 0
    buffer_load_dwordx4 v1, s[12:15], s59 offen offset:0 sc1 lds
    buffer_load_dwordx4 v1, s[12:15], s59 offen offset:1024 sc1 lds
    buffer_load_dwordx4 v1, s[12:15], s59 offen offset:2048 sc1 lds
    buffer_load_dwordx4 v1, s[12:15], s59 offen offset:3072 sc1 lds
    s_add_u32 m0, s53, 4096
    s_add_u32 s59, s54, 4096
    buffer_load_dwordx4 v1, s[12:15], s59 offen offset:0 sc1 lds
    buffer_load_dwordx4 v1, s[12:15], s59 offen offset:1024 sc1 lds
    buffer_load_dwordx4 v1, s[12:15], s59 offen offset:2048 sc1 lds
    buffer_load_dwordx4 v1, s[12:15], s59 offen offset:3072 sc1 lds
    s_add_u32 m0, s53, 16384
    s_add_u32 s59, s54, 8192
    buffer_load_dwordx4 v1, s[12:15], s59 offen offset:0 sc1 lds
    buffer_load_dwordx4 v1, s[12:15], s59 offen offset:1024 sc1 lds
    buffer_load_dwordx4 v1, s[12:15], s59 offen offset:2048 sc1 lds
    buffer_load_dwordx4 v1, s[12:15], s59 offen offset:3072 sc1 lds
    s_add_u32 m0, s53, 20480
    s_add_u32 s59, s54, 12288
    buffer_load_dwordx4 v1, s[12:15], s59 offen offset:0 sc1 lds
    buffer_load_dwordx4 v1, s[12:15], s59 offen offset:1024 sc1 lds
    buffer_load_dwordx4 v1, s[12:15], s59 offen offset:2048 sc1 lds
    buffer_load_dwordx4 v1, s[12:15], s59 offen offset:3072 sc1 lds
    s_add_u32 m0, s53, 32768
    s_add_u32 s59, s54, 16384
    buffer_load_dwordx4 v1, s[12:15], s59 offen offset:0 sc1 lds
    buffer_load_dwordx4 v1, s[12:15], s59 offen offset:1024 sc1 lds
    buffer_load_dwordx4 v1, s[12:15], s59 offen offset:2048 sc1 lds
    buffer_load_dwordx4 v1, s[12:15], s59 offen offset:3072 sc1 lds
    s_add_u32 m0, s53, 36864
    s_add_u32 s59, s54, 20480
    buffer_load_dwordx4 v1, s[12:15], s59 offen offset:0 sc1 lds
    buffer_load_dwordx4 v1, s[12:15], s59 offen offset:1024 sc1 lds
    buffer_load_dwordx4 v1, s[12:15], s59 offen offset:2048 sc1 lds
    buffer_load_dwordx4 v1, s[12:15], s59 offen offset:3072 sc1 lds
    s_branch mega_kernel_t5j62
mega_kernel_t5g60:
    s_add_u32 m0, s53, 0
    s_add_u32 s59, s54, 0
    buffer_load_dwordx4 v1, s[12:15], s59 offen offset:0 sc1 lds
    buffer_load_dwordx4 v1, s[12:15], s59 offen offset:1024 sc1 lds
    buffer_load_dwordx4 v1, s[12:15], s59 offen offset:2048 sc1 lds
    buffer_load_dwordx4 v1, s[12:15], s59 offen offset:3072 sc1 lds
    s_add_u32 m0, s53, 4096
    s_add_u32 s59, s54, 4096
    buffer_load_dwordx4 v1, s[12:15], s59 offen offset:0 sc1 lds
    buffer_load_dwordx4 v1, s[12:15], s59 offen offset:1024 sc1 lds
    buffer_load_dwordx4 v1, s[12:15], s59 offen offset:2048 sc1 lds
    buffer_load_dwordx4 v1, s[12:15], s59 offen offset:3072 sc1 lds
    s_add_u32 m0, s53, 16384
    s_add_u32 s59, s54, 8192
    buffer_load_dwordx4 v1, s[12:15], s59 offen offset:0 sc1 lds
    buffer_load_dwordx4 v1, s[12:15], s59 offen offset:1024 sc1 lds
    buffer_load_dwordx4 v1, s[12:15], s59 offen offset:2048 sc1 lds
    buffer_load_dwordx4 v1, s[12:15], s59 offen offset:3072 sc1 lds
    s_add_u32 m0, s53, 20480
    s_add_u32 s59, s54, 12288
    buffer_load_dwordx4 v1, s[12:15], s59 offen offset:0 sc1 lds
    buffer_load_dwordx4 v1, s[12:15], s59 offen offset:1024 sc1 lds
    buffer_load_dwordx4 v1, s[12:15], s59 offen offset:2048 sc1 lds
    buffer_load_dwordx4 v1, s[12:15], s59 offen offset:3072 sc1 lds
    s_add_u32 m0, s53, 32768
    s_add_u32 s59, s54, 16384
    buffer_load_dwordx4 v1, s[12:15], s59 offen offset:0 sc1 lds
    buffer_load_dwordx4 v1, s[12:15], s59 offen offset:1024 sc1 lds
    buffer_load_dwordx4 v1, s[12:15], s59 offen offset:2048 sc1 lds
    buffer_load_dwordx4 v1, s[12:15], s59 offen offset:3072 sc1 lds
    s_add_u32 m0, s53, 36864
    s_add_u32 s59, s54, 20480
    buffer_load_dwordx4 v1, s[12:15], s59 offen offset:0 sc1 lds
    buffer_load_dwordx4 v1, s[12:15], s59 offen offset:1024 sc1 lds
    buffer_load_dwordx4 v1, s[12:15], s59 offen offset:2048 sc1 lds
    buffer_load_dwordx4 v1, s[12:15], s59 offen offset:3072 sc1 lds
    s_waitcnt lgkmcnt(0)
    s_barrier
mega_kernel_t5j62:
mega_kernel_le56:
    s_and_b32 s30, s19, 1
    s_cmp_ge_u32 s19, 2
    s_cbranch_scc1 mega_kernel_la71
    s_add_u32 m0, s53, 114688
    s_add_u32 s59, s52, 49152
    buffer_load_dwordx4 v1, s[12:15], s59 offen offset:0 sc1 lds
    buffer_load_dwordx4 v1, s[12:15], s59 offen offset:1024 sc1 lds
    buffer_load_dwordx4 v1, s[12:15], s59 offen offset:2048 sc1 lds
    buffer_load_dwordx4 v1, s[12:15], s59 offen offset:3072 sc1 lds
    s_add_u32 m0, s53, 118784
    s_add_u32 s59, s52, 53248
    buffer_load_dwordx4 v1, s[12:15], s59 offen offset:0 sc1 lds
    buffer_load_dwordx4 v1, s[12:15], s59 offen offset:1024 sc1 lds
    buffer_load_dwordx4 v1, s[12:15], s59 offen offset:2048 sc1 lds
    buffer_load_dwordx4 v1, s[12:15], s59 offen offset:3072 sc1 lds
    s_add_u32 m0, s53, 147456
    s_add_u32 s59, s52, 65536
    buffer_load_dwordx4 v1, s[12:15], s59 offen offset:0 sc1 lds
    buffer_load_dwordx4 v1, s[12:15], s59 offen offset:1024 sc1 lds
    buffer_load_dwordx4 v1, s[12:15], s59 offen offset:2048 sc1 lds
    buffer_load_dwordx4 v1, s[12:15], s59 offen offset:3072 sc1 lds
    s_add_u32 m0, s53, 151552
    s_add_u32 s59, s52, 69632
    buffer_load_dwordx4 v1, s[12:15], s59 offen offset:0 sc1 lds
    buffer_load_dwordx4 v1, s[12:15], s59 offen offset:1024 sc1 lds
    buffer_load_dwordx4 v1, s[12:15], s59 offen offset:2048 sc1 lds
    buffer_load_dwordx4 v1, s[12:15], s59 offen offset:3072 sc1 lds
    s_waitcnt vmcnt(32)
    s_barrier
    s_waitcnt vmcnt(24)
    s_barrier
    s_waitcnt vmcnt(16)
    s_barrier
    s_add_u32 m0, s53, 65536
    s_add_u32 s59, s52, 81920
    buffer_load_dwordx4 v1, s[12:15], s59 offen offset:0 sc1 lds
    buffer_load_dwordx4 v1, s[12:15], s59 offen offset:1024 sc1 lds
    buffer_load_dwordx4 v1, s[12:15], s59 offen offset:2048 sc1 lds
    buffer_load_dwordx4 v1, s[12:15], s59 offen offset:3072 sc1 lds
    s_add_u32 m0, s53, 69632
    s_add_u32 s59, s52, 86016
    buffer_load_dwordx4 v1, s[12:15], s59 offen offset:0 sc1 lds
    buffer_load_dwordx4 v1, s[12:15], s59 offen offset:1024 sc1 lds
    buffer_load_dwordx4 v1, s[12:15], s59 offen offset:2048 sc1 lds
    buffer_load_dwordx4 v1, s[12:15], s59 offen offset:3072 sc1 lds
    s_waitcnt vmcnt(16)
    s_barrier
    s_add_u32 m0, s53, 81920
    s_add_u32 s59, s52, 98304
    buffer_load_dwordx4 v1, s[12:15], s59 offen offset:0 sc1 lds
    buffer_load_dwordx4 v1, s[12:15], s59 offen offset:1024 sc1 lds
    buffer_load_dwordx4 v1, s[12:15], s59 offen offset:2048 sc1 lds
    buffer_load_dwordx4 v1, s[12:15], s59 offen offset:3072 sc1 lds
    s_add_u32 m0, s53, 86016
    s_add_u32 s59, s52, 102400
    buffer_load_dwordx4 v1, s[12:15], s59 offen offset:0 sc1 lds
    buffer_load_dwordx4 v1, s[12:15], s59 offen offset:1024 sc1 lds
    buffer_load_dwordx4 v1, s[12:15], s59 offen offset:2048 sc1 lds
    buffer_load_dwordx4 v1, s[12:15], s59 offen offset:3072 sc1 lds
    s_waitcnt vmcnt(16)
    s_barrier
    s_add_u32 m0, s53, 98304
    s_add_u32 s59, s52, 114688
    buffer_load_dwordx4 v1, s[12:15], s59 offen offset:0 sc1 lds
    buffer_load_dwordx4 v1, s[12:15], s59 offen offset:1024 sc1 lds
    buffer_load_dwordx4 v1, s[12:15], s59 offen offset:2048 sc1 lds
    buffer_load_dwordx4 v1, s[12:15], s59 offen offset:3072 sc1 lds
    s_add_u32 m0, s53, 102400
    s_add_u32 s59, s52, 118784
    buffer_load_dwordx4 v1, s[12:15], s59 offen offset:0 sc1 lds
    buffer_load_dwordx4 v1, s[12:15], s59 offen offset:1024 sc1 lds
    buffer_load_dwordx4 v1, s[12:15], s59 offen offset:2048 sc1 lds
    buffer_load_dwordx4 v1, s[12:15], s59 offen offset:3072 sc1 lds
    s_waitcnt vmcnt(16)
    s_barrier
    s_add_u32 m0, s53, 114688
    s_add_u32 s59, s52, 131072
    buffer_load_dwordx4 v1, s[12:15], s59 offen offset:0 sc1 lds
    buffer_load_dwordx4 v1, s[12:15], s59 offen offset:1024 sc1 lds
    buffer_load_dwordx4 v1, s[12:15], s59 offen offset:2048 sc1 lds
    buffer_load_dwordx4 v1, s[12:15], s59 offen offset:3072 sc1 lds
    s_add_u32 m0, s53, 118784
    s_add_u32 s59, s52, 135168
    buffer_load_dwordx4 v1, s[12:15], s59 offen offset:0 sc1 lds
    buffer_load_dwordx4 v1, s[12:15], s59 offen offset:1024 sc1 lds
    buffer_load_dwordx4 v1, s[12:15], s59 offen offset:2048 sc1 lds
    buffer_load_dwordx4 v1, s[12:15], s59 offen offset:3072 sc1 lds
    s_waitcnt vmcnt(16)
    s_barrier
    s_add_u32 m0, s53, 147456
    s_add_u32 s59, s52, 147456
    buffer_load_dwordx4 v1, s[12:15], s59 offen offset:0 sc1 lds
    buffer_load_dwordx4 v1, s[12:15], s59 offen offset:1024 sc1 lds
    buffer_load_dwordx4 v1, s[12:15], s59 offen offset:2048 sc1 lds
    buffer_load_dwordx4 v1, s[12:15], s59 offen offset:3072 sc1 lds
    s_add_u32 m0, s53, 151552
    s_add_u32 s59, s52, 151552
    buffer_load_dwordx4 v1, s[12:15], s59 offen offset:0 sc1 lds
    buffer_load_dwordx4 v1, s[12:15], s59 offen offset:1024 sc1 lds
    buffer_load_dwordx4 v1, s[12:15], s59 offen offset:2048 sc1 lds
    buffer_load_dwordx4 v1, s[12:15], s59 offen offset:3072 sc1 lds
    s_waitcnt vmcnt(16)
    s_barrier
    s_add_u32 m0, s53, 65536
    s_add_u32 s59, s52, 163840
    buffer_load_dwordx4 v1, s[12:15], s59 offen offset:0 sc1 lds
    buffer_load_dwordx4 v1, s[12:15], s59 offen offset:1024 sc1 lds
    buffer_load_dwordx4 v1, s[12:15], s59 offen offset:2048 sc1 lds
    buffer_load_dwordx4 v1, s[12:15], s59 offen offset:3072 sc1 lds
    s_add_u32 m0, s53, 69632
    s_add_u32 s59, s52, 167936
    buffer_load_dwordx4 v1, s[12:15], s59 offen offset:0 sc1 lds
    buffer_load_dwordx4 v1, s[12:15], s59 offen offset:1024 sc1 lds
    buffer_load_dwordx4 v1, s[12:15], s59 offen offset:2048 sc1 lds
    buffer_load_dwordx4 v1, s[12:15], s59 offen offset:3072 sc1 lds
    s_waitcnt vmcnt(16)
    s_barrier
    s_add_u32 m0, s53, 81920
    s_add_u32 s59, s52, 180224
    buffer_load_dwordx4 v1, s[12:15], s59 offen offset:0 sc1 lds
    buffer_load_dwordx4 v1, s[12:15], s59 offen offset:1024 sc1 lds
    buffer_load_dwordx4 v1, s[12:15], s59 offen offset:2048 sc1 lds
    buffer_load_dwordx4 v1, s[12:15], s59 offen offset:3072 sc1 lds
    s_add_u32 m0, s53, 86016
    s_add_u32 s59, s52, 184320
    buffer_load_dwordx4 v1, s[12:15], s59 offen offset:0 sc1 lds
    buffer_load_dwordx4 v1, s[12:15], s59 offen offset:1024 sc1 lds
    buffer_load_dwordx4 v1, s[12:15], s59 offen offset:2048 sc1 lds
    buffer_load_dwordx4 v1, s[12:15], s59 offen offset:3072 sc1 lds
    s_waitcnt vmcnt(16)
    s_barrier
    s_add_u32 m0, s53, 98304
    s_add_u32 s59, s52, 196608
    buffer_load_dwordx4 v1, s[12:15], s59 offen offset:0 sc1 lds
    buffer_load_dwordx4 v1, s[12:15], s59 offen offset:1024 sc1 lds
    buffer_load_dwordx4 v1, s[12:15], s59 offen offset:2048 sc1 lds
    buffer_load_dwordx4 v1, s[12:15], s59 offen offset:3072 sc1 lds
    s_add_u32 m0, s53, 102400
    s_add_u32 s59, s52, 200704
    buffer_load_dwordx4 v1, s[12:15], s59 offen offset:0 sc1 lds
    buffer_load_dwordx4 v1, s[12:15], s59 offen offset:1024 sc1 lds
    buffer_load_dwordx4 v1, s[12:15], s59 offen offset:2048 sc1 lds
    buffer_load_dwordx4 v1, s[12:15], s59 offen offset:3072 sc1 lds
    s_waitcnt vmcnt(16)
    s_barrier
    s_add_u32 m0, s53, 114688
    s_add_u32 s59, s52, 212992
    buffer_load_dwordx4 v1, s[12:15], s59 offen offset:0 sc1 lds
    buffer_load_dwordx4 v1, s[12:15], s59 offen offset:1024 sc1 lds
    buffer_load_dwordx4 v1, s[12:15], s59 offen offset:2048 sc1 lds
    buffer_load_dwordx4 v1, s[12:15], s59 offen offset:3072 sc1 lds
    s_add_u32 m0, s53, 118784
    s_add_u32 s59, s52, 217088
    buffer_load_dwordx4 v1, s[12:15], s59 offen offset:0 sc1 lds
    buffer_load_dwordx4 v1, s[12:15], s59 offen offset:1024 sc1 lds
    buffer_load_dwordx4 v1, s[12:15], s59 offen offset:2048 sc1 lds
    buffer_load_dwordx4 v1, s[12:15], s59 offen offset:3072 sc1 lds
    s_waitcnt vmcnt(16)
    s_barrier
    s_waitcnt vmcnt(8)
    s_barrier
    s_waitcnt vmcnt(0)
    s_barrier
    s_barrier
    s_branch mega_kernel_le72
mega_kernel_la71:
    s_add_u32 m0, s53, 49152
    s_add_u32 s59, s54, 24576
    buffer_load_dwordx4 v1, s[12:15], s59 offen offset:0 sc1 lds
    buffer_load_dwordx4 v1, s[12:15], s59 offen offset:1024 sc1 lds
    buffer_load_dwordx4 v1, s[12:15], s59 offen offset:2048 sc1 lds
    buffer_load_dwordx4 v1, s[12:15], s59 offen offset:3072 sc1 lds
    s_add_u32 m0, s53, 53248
    s_add_u32 s59, s54, 28672
    buffer_load_dwordx4 v1, s[12:15], s59 offen offset:0 sc1 lds
    buffer_load_dwordx4 v1, s[12:15], s59 offen offset:1024 sc1 lds
    buffer_load_dwordx4 v1, s[12:15], s59 offen offset:2048 sc1 lds
    buffer_load_dwordx4 v1, s[12:15], s59 offen offset:3072 sc1 lds
    s_add_u32 m0, s53, 131072
    s_add_u32 s59, s54, 32768
    buffer_load_dwordx4 v1, s[12:15], s59 offen offset:0 sc1 lds
    buffer_load_dwordx4 v1, s[12:15], s59 offen offset:1024 sc1 lds
    buffer_load_dwordx4 v1, s[12:15], s59 offen offset:2048 sc1 lds
    buffer_load_dwordx4 v1, s[12:15], s59 offen offset:3072 sc1 lds
    s_add_u32 m0, s53, 135168
    s_add_u32 s59, s54, 36864
    buffer_load_dwordx4 v1, s[12:15], s59 offen offset:0 sc1 lds
    buffer_load_dwordx4 v1, s[12:15], s59 offen offset:1024 sc1 lds
    buffer_load_dwordx4 v1, s[12:15], s59 offen offset:2048 sc1 lds
    buffer_load_dwordx4 v1, s[12:15], s59 offen offset:3072 sc1 lds
    s_waitcnt vmcnt(32)
    s_barrier
    s_waitcnt vmcnt(24)
    s_barrier
    s_waitcnt vmcnt(16)
    s_barrier
    s_add_u32 m0, s53, 0
    s_add_u32 s59, s54, 40960
    buffer_load_dwordx4 v1, s[12:15], s59 offen offset:0 sc1 lds
    buffer_load_dwordx4 v1, s[12:15], s59 offen offset:1024 sc1 lds
    buffer_load_dwordx4 v1, s[12:15], s59 offen offset:2048 sc1 lds
    buffer_load_dwordx4 v1, s[12:15], s59 offen offset:3072 sc1 lds
    s_add_u32 m0, s53, 4096
    s_add_u32 s59, s54, 45056
    buffer_load_dwordx4 v1, s[12:15], s59 offen offset:0 sc1 lds
    buffer_load_dwordx4 v1, s[12:15], s59 offen offset:1024 sc1 lds
    buffer_load_dwordx4 v1, s[12:15], s59 offen offset:2048 sc1 lds
    buffer_load_dwordx4 v1, s[12:15], s59 offen offset:3072 sc1 lds
    s_waitcnt vmcnt(16)
    s_barrier
    s_add_u32 m0, s53, 16384
    s_add_u32 s59, s54, 49152
    buffer_load_dwordx4 v1, s[12:15], s59 offen offset:0 sc1 lds
    buffer_load_dwordx4 v1, s[12:15], s59 offen offset:1024 sc1 lds
    buffer_load_dwordx4 v1, s[12:15], s59 offen offset:2048 sc1 lds
    buffer_load_dwordx4 v1, s[12:15], s59 offen offset:3072 sc1 lds
    s_add_u32 m0, s53, 20480
    s_add_u32 s59, s54, 53248
    buffer_load_dwordx4 v1, s[12:15], s59 offen offset:0 sc1 lds
    buffer_load_dwordx4 v1, s[12:15], s59 offen offset:1024 sc1 lds
    buffer_load_dwordx4 v1, s[12:15], s59 offen offset:2048 sc1 lds
    buffer_load_dwordx4 v1, s[12:15], s59 offen offset:3072 sc1 lds
    s_add_u32 s40, s40, 65536
    v_mov_b32 v2, 0
    buffer_load_dword v3, v2, s[12:15], s40 offen sc1
    s_waitcnt vmcnt(17)
    s_barrier
    s_add_u32 m0, s53, 32768
    s_add_u32 s59, s54, 57344
    buffer_load_dwordx4 v1, s[12:15], s59 offen offset:0 sc1 lds
    buffer_load_dwordx4 v1, s[12:15], s59 offen offset:1024 sc1 lds
    buffer_load_dwordx4 v1, s[12:15], s59 offen offset:2048 sc1 lds
    buffer_load_dwordx4 v1, s[12:15], s59 offen offset:3072 sc1 lds
    s_add_u32 m0, s53, 36864
    s_add_u32 s59, s54, 61440
    buffer_load_dwordx4 v1, s[12:15], s59 offen offset:0 sc1 lds
    buffer_load_dwordx4 v1, s[12:15], s59 offen offset:1024 sc1 lds
    buffer_load_dwordx4 v1, s[12:15], s59 offen offset:2048 sc1 lds
    buffer_load_dwordx4 v1, s[12:15], s59 offen offset:3072 sc1 lds
    s_waitcnt vmcnt(17)
    s_barrier
    s_waitcnt vmcnt(8)
    v_readfirstlane_b32 s50, v3
    s_nop 0
    s_cmp_ge_u32 s50, 16
    s_cbranch_scc1 mega_kernel_hb73
    v_mov_b32 v2, 0
    s_mov_b32 s49, 0x4000
mega_kernel_pl74:
    buffer_load_dword v28, v2, s[12:15], s40 offen sc1
    s_waitcnt vmcnt(0)
    v_readfirstlane_b32 s50, v28
    s_nop 0
    s_cmp_ge_u32 s50, 16
    s_cbranch_scc1 mega_kernel_pd75
    s_sleep 1
    s_sub_u32 s49, s49, 1
    s_cmp_lg_u32 s49, 0
    s_cbranch_scc1 mega_kernel_pl74
mega_kernel_pd75:
mega_kernel_hb73:
    s_add_u32 m0, s53, 49152
    s_add_u32 s59, s54, 65536
    buffer_load_dwordx4 v1, s[12:15], s59 offen offset:0 sc1 lds
    buffer_load_dwordx4 v1, s[12:15], s59 offen offset:1024 sc1 lds
    buffer_load_dwordx4 v1, s[12:15], s59 offen offset:2048 sc1 lds
    buffer_load_dwordx4 v1, s[12:15], s59 offen offset:3072 sc1 lds
    s_add_u32 m0, s53, 53248
    s_add_u32 s59, s54, 69632
    buffer_load_dwordx4 v1, s[12:15], s59 offen offset:0 sc1 lds
    buffer_load_dwordx4 v1, s[12:15], s59 offen offset:1024 sc1 lds
    buffer_load_dwordx4 v1, s[12:15], s59 offen offset:2048 sc1 lds
    buffer_load_dwordx4 v1, s[12:15], s59 offen offset:3072 sc1 lds
    s_waitcnt vmcnt(16)
    s_barrier
    s_add_u32 m0, s53, 131072
    s_add_u32 s59, s54, 73728
    buffer_load_dwordx4 v1, s[12:15], s59 offen offset:0 sc1 lds
    buffer_load_dwordx4 v1, s[12:15], s59 offen offset:1024 sc1 lds
    buffer_load_dwordx4 v1, s[12:15], s59 offen offset:2048 sc1 lds
    buffer_load_dwordx4 v1, s[12:15], s59 offen offset:3072 sc1 lds
    s_add_u32 m0, s53, 135168
    s_add_u32 s59, s54, 77824
    buffer_load_dwordx4 v1, s[12:15], s59 offen offset:0 sc1 lds
    buffer_load_dwordx4 v1, s[12:15], s59 offen offset:1024 sc1 lds
    buffer_load_dwordx4 v1, s[12:15], s59 offen offset:2048 sc1 lds
    buffer_load_dwordx4 v1, s[12:15], s59 offen offset:3072 sc1 lds
    s_waitcnt vmcnt(16)
    s_barrier
    s_add_u32 m0, s53, 0
    s_add_u32 s59, s54, 81920
    buffer_load_dwordx4 v1, s[12:15], s59 offen offset:0 sc1 lds
    buffer_load_dwordx4 v1, s[12:15], s59 offen offset:1024 sc1 lds
    buffer_load_dwordx4 v1, s[12:15], s59 offen offset:2048 sc1 lds
    buffer_load_dwordx4 v1, s[12:15], s59 offen offset:3072 sc1 lds
    s_add_u32 m0, s53, 4096
    s_add_u32 s59, s54, 86016
    buffer_load_dwordx4 v1, s[12:15], s59 offen offset:0 sc1 lds
    buffer_load_dwordx4 v1, s[12:15], s59 offen offset:1024 sc1 lds
    buffer_load_dwordx4 v1, s[12:15], s59 offen offset:2048 sc1 lds
    buffer_load_dwordx4 v1, s[12:15], s59 offen offset:3072 sc1 lds
    s_waitcnt vmcnt(16)
    s_barrier
    s_add_u32 m0, s53, 16384
    s_add_u32 s59, s54, 90112
    buffer_load_dwordx4 v1, s[12:15], s59 offen offset:0 sc1 lds
    buffer_load_dwordx4 v1, s[12:15], s59 offen offset:1024 sc1 lds
    buffer_load_dwordx4 v1, s[12:15], s59 offen offset:2048 sc1 lds
    buffer_load_dwordx4 v1, s[12:15], s59 offen offset:3072 sc1 lds
    s_add_u32 m0, s53, 20480
    s_add_u32 s59, s54, 94208
    buffer_load_dwordx4 v1, s[12:15], s59 offen offset:0 sc1 lds
    buffer_load_dwordx4 v1, s[12:15], s59 offen offset:1024 sc1 lds
    buffer_load_dwordx4 v1, s[12:15], s59 offen offset:2048 sc1 lds
    buffer_load_dwordx4 v1, s[12:15], s59 offen offset:3072 sc1 lds
    s_waitcnt vmcnt(16)
    s_barrier
    s_add_u32 m0, s53, 32768
    s_add_u32 s59, s54, 98304
    buffer_load_dwordx4 v1, s[12:15], s59 offen offset:0 sc1 lds
    buffer_load_dwordx4 v1, s[12:15], s59 offen offset:1024 sc1 lds
    buffer_load_dwordx4 v1, s[12:15], s59 offen offset:2048 sc1 lds
    buffer_load_dwordx4 v1, s[12:15], s59 offen offset:3072 sc1 lds
    s_add_u32 m0, s53, 36864
    s_add_u32 s59, s54, 102400
    buffer_load_dwordx4 v1, s[12:15], s59 offen offset:0 sc1 lds
    buffer_load_dwordx4 v1, s[12:15], s59 offen offset:1024 sc1 lds
    buffer_load_dwordx4 v1, s[12:15], s59 offen offset:2048 sc1 lds
    buffer_load_dwordx4 v1, s[12:15], s59 offen offset:3072 sc1 lds
    s_waitcnt vmcnt(16)
    s_barrier
    s_add_u32 m0, s53, 49152
    s_add_u32 s59, s54, 106496
    buffer_load_dwordx4 v1, s[12:15], s59 offen offset:0 sc1 lds
    buffer_load_dwordx4 v1, s[12:15], s59 offen offset:1024 sc1 lds
    buffer_load_dwordx4 v1, s[12:15], s59 offen offset:2048 sc1 lds
    buffer_load_dwordx4 v1, s[12:15], s59 offen offset:3072 sc1 lds
    s_add_u32 m0, s53, 53248
    s_add_u32 s59, s54, 110592
    buffer_load_dwordx4 v1, s[12:15], s59 offen offset:0 sc1 lds
    buffer_load_dwordx4 v1, s[12:15], s59 offen offset:1024 sc1 lds
    buffer_load_dwordx4 v1, s[12:15], s59 offen offset:2048 sc1 lds
    buffer_load_dwordx4 v1, s[12:15], s59 offen offset:3072 sc1 lds
    s_waitcnt vmcnt(16)
    s_barrier
    s_waitcnt vmcnt(8)
    s_barrier
    s_waitcnt vmcnt(0)
    s_barrier
    s_barrier
mega_kernel_le72:
    s_add_u32 s18, s18, 1
    s_add_u32 s16, s16, 25165824
    s_add_u32 s17, s17, 196608
    s_cmp_lt_u32 s18, 2
    s_cbranch_scc1 mega_kernel_ltop
    s_endpgm
mega_kernel_end:
    s_endpgm
.section .rodata,"a"
.p2align 6
.amdhsa_kernel mega_kernel
  .amdhsa_next_free_vgpr 168
  .amdhsa_next_free_sgpr 100
  .amdhsa_accum_offset 168
  .amdhsa_group_segment_fixed_size 0
  .amdhsa_kernarg_size 80
  .amdhsa_user_sgpr_count 2
  .amdhsa_user_sgpr_kernarg_segment_ptr 1
  .amdhsa_system_sgpr_workgroup_id_x 1
.end_amdhsa_kernel
.text
```
